```python
import torch

def _softmax(x, axis=-1):
    return torch.softmax(x, dim=axis)
def _gelu(x):
    return torch.nn.functional.gelu(x, approximate="tanh")
def _silu(x):
    return torch.nn.functional.silu(x)
def _sigmoid(x):
    return torch.sigmoid(x)
def _layernorm(x, axis=-1, eps=1e-5):
    m = x.mean(dim=axis, keepdim=True)
    v = x.var(dim=axis, keepdim=True, unbiased=False)
    return (x - m) / torch.sqrt(v + eps)
def _scatter_add(tgt, idx, src, axis=0):
    return tgt.clone().index_add_(axis, idx, src)
def _segment_sum(src, seg, n):
    out = torch.zeros((n,) + src.shape[1:], dtype=src.dtype)
    return out.index_add_(0, seg, src)
def _pad(x, pw):
    flat = tuple(v for pair in reversed(pw) for v in pair)
    return torch.nn.functional.pad(x, flat)

kernel_name = 'gated_mix__mha_block_cached__dense_activation_gelu__decode'

def setup_inputs():

    _w = (lambda a: (lambda t: t.to(torch.bfloat16) if t.is_floating_point() else t)(torch.as_tensor(a)))
    def _A_setup():
        B, Sq, D = 2, 1, 448
        H, Sk, Dh = 16, 4096, 256
        return {
            "x": _w((lambda *s: torch.randn(*s, dtype=torch.bfloat16) * 0.05)(B, Sq, D)),
            "k_cache": _w((lambda *s: torch.randn(*s, dtype=torch.bfloat16) * 6.4)(B, H, Sk, Dh)),
            "v_cache": _w((lambda *s: torch.randn(*s, dtype=torch.bfloat16) * 0.4)(B, H, Sk, Dh)),
            "wq": _w((lambda *s: torch.randn(*s, dtype=torch.bfloat16) * 6.4)(D, H * Dh) * (D ** -0.5)),
            "wo": _w((lambda *s: torch.randn(*s, dtype=torch.bfloat16) * 0.4)(H * Dh, D) * ((H * Dh) ** -0.5)),
        }
    _A_in = _A_setup()

    def _B_setup():
        B, S, D, F = 2, 1, 448, 1792
        return {
            "x": _w((lambda *s: torch.randn(*s, dtype=torch.bfloat16) * 0.05)(B, S, D)),
            "w1": _w((lambda *s: torch.randn(*s, dtype=torch.bfloat16) * 3.2)(D, F) * (D ** -0.5)),
            "b1": _w((lambda *s: torch.randn(*s, dtype=torch.bfloat16) * 3.2)(F) * 0.01),
            "w2": _w((lambda *s: torch.randn(*s, dtype=torch.bfloat16) * 0.4)(F, D) * (F ** -0.5)),
            "b2": _w((lambda *s: torch.randn(*s, dtype=torch.bfloat16) * 0.8)(D) * 0.01),
        }
    _B_in = _B_setup()

    return {
        "A_x": _A_in["x"],
        "A_k_cache": _A_in["k_cache"],
        "A_v_cache": _A_in["v_cache"],
        "A_wq": _A_in["wq"],
        "A_wo": _A_in["wo"],
        "B_x": _B_in["x"],
        "B_w1": _B_in["w1"],
        "B_b1": _B_in["b1"],
        "B_w2": _B_in["w2"],
        "B_b2": _B_in["b2"],
        "gate_w": _w((lambda *s: torch.randn(*s, dtype=torch.bfloat16) * 0.1)(448) * 16.0),
    }

def reference(A_x, A_k_cache, A_v_cache, A_wq, A_wo, B_x, B_w1, B_b1, B_w2, B_b2, gate_w):
    def _A_ref(x, k_cache, v_cache, wq, wo):
        B, Sq, D = x.shape
        H, Dh = 16, 256
        q = (lambda x, *d: x.permute(*d))((x @ wq).reshape(B, Sq, H, Dh), 0, 2, 1, 3)
        scores = torch.einsum("bhqd,bhkd->bhqk", q, k_cache) * (Dh ** -0.5)
        p = _softmax(scores, axis=-1)
        o = torch.einsum("bhqk,bhkd->bhqd", p, v_cache)
        return (lambda x, *d: x.permute(*d))(o, 0, 2, 1, 3).reshape(B, Sq, H * Dh) @ wo

    def _B_ref(x, w1, b1, w2, b2):
        h = torch.einsum("bsd,df->bsf", x, w1) + b1
        h = _gelu(h)
        return torch.einsum("bsf,fd->bsd", h, w2) + b2

    x = A_x
    g = _sigmoid((x * gate_w).sum(-1, keepdims=True))
    a = _A_ref(x, A_k_cache, A_v_cache, A_wq, A_wo)
    b = _B_ref(x, B_w1, B_b1, B_w2, B_b2)
    return g * a + (1 - g) * b
```

```asm
; @launch grid=(256,1,1) block=(512,1,1) lds=20480
.amdgcn_target "amdgcn-amd-amdhsa--gfx950"
.text
.globl gated_mix__mha_block_cached__dense_activation_gelu__decode_kernel
.p2align 8
.type gated_mix__mha_block_cached__dense_activation_gelu__decode_kernel,@function
gated_mix__mha_block_cached__dense_activation_gelu__decode_kernel:
    s_cmp_ge_u32 s2, 256
    s_cbranch_scc1 L_end
    s_load_dwordx16 s[4:19], s[0:1], 0
    s_load_dwordx8 s[20:27], s[0:1], 64
    s_load_dwordx4 s[28:31], s[0:1], 96
    s_memrealtime s[100:101]
    v_lshrrev_b32 v3, 6, v0
    v_and_b32 v1, 63, v0
    v_readfirstlane_b32 s32, v3
    s_bfe_u32 s33, s2, 0x10005
    s_bfe_u32 s74, s2, 0x10006
    s_lshl_b32 s74, s74, 1
    s_or_b32 s33, s33, s74
    s_bfe_u32 s74, s2, 0x10007
    s_lshl_b32 s74, s74, 2
    s_or_b32 s33, s33, s74
    s_bfe_u32 s74, s2, 0x10002
    s_lshl_b32 s74, s74, 3
    s_or_b32 s33, s33, s74
    s_bfe_u32 s35, s2, 0x10001
    s_bfe_u32 s74, s2, 0x10003
    s_lshl_b32 s74, s74, 1
    s_or_b32 s35, s35, s74
    s_bfe_u32 s74, s2, 0x10004
    s_lshl_b32 s74, s74, 2
    s_or_b32 s35, s35, s74
    s_bfe_u32 s74, s2, 0x10000
    s_lshl_b32 s74, s74, 3
    s_or_b32 s35, s35, s74
    s_mov_b32 s3, s33
    s_and_b32 s34, s35, 1
    s_bfe_u32 s75, s35, 0x20001
    s_lshr_b32 s76, s35, 3
    s_lshl_b32 s73, s35, 4
    s_or_b32 s73, s73, s33
    s_lshl_b32 s73, s73, 12
    v_and_b32 v44, 15, v1
    v_lshrrev_b32 v45, 4, v1
    v_lshlrev_b32 v44, 4, v44
    v_lshl_add_u32 v2, v45, 9, v44
    v_mov_b32 v3, 0x3ff
    s_lshl_b32 s74, s34, 4
    s_add_u32 s74, s74, s33
    s_lshl_b32 s74, s74, 21
    s_lshl_b32 s76, s76, 2
    s_or_b32 s75, s75, s76
    s_lshl_b32 s75, s75, 18
    s_add_u32 s74, s74, s75
    s_lshl_b32 s75, s32, 12
    s_add_u32 s74, s74, s75
    s_mov_b32 s72, 233472
    s_mov_b32 s65, 32768
    s_mov_b32 s66, 65536
    s_mov_b32 s67, 98304
    s_mov_b32 s68, 131072
    s_mov_b32 s69, 163840
    s_mov_b32 s70, 196608
    s_mov_b32 s71, 229376
    s_and_b32 s75, s35, 3
    s_mul_i32 s75, s75, 112
    s_lshl_b32 s76, s32, 4
    s_add_u32 s75, s75, s76
    s_sub_u32 s75, s75, 16
    s_lshl_b32 s76, s75, 13
    s_lshl_b32 s77, s33, 9
    s_add_u32 s76, s76, s77
    s_lshr_b32 s77, s35, 2
    s_lshl_b32 s77, s77, 7
    s_add_u32 s76, s76, s77
    s_lshl_b32 s75, s75, 1
    s_waitcnt lgkmcnt(0)
    s_lshr_b32 s14, s35, 2
    s_lshl_b32 s15, s33, 2
    s_add_u32 s14, s14, s15
    s_and_b32 s15, s35, 3
    s_cmp_eq_u32 s32, 0
    s_cbranch_scc1 L_service
    s_add_u32 s48, s10, s76
    s_addc_u32 s49, s11, 0
    s_mov_b32 s50, 123008
    s_mov_b32 s51, 0x20000
    s_mov_b32 s52, s4
    s_mov_b32 s53, s5
    s_mov_b32 s54, 1792
    s_mov_b32 s55, 0x20000
    v_lshrrev_b32 v44, 3, v1
    v_and_b32 v45, 7, v1
    v_lshlrev_b32 v45, 4, v45
    v_lshl_add_u32 v44, v44, 13, v45
    s_mov_b32 s77, 65536
    buffer_load_dwordx4 v[208:211], v44, s[48:51], 0 offen nt
    buffer_load_dwordx4 v[212:215], v44, s[48:51], s77 offen nt
    v_bfe_u32 v46, v1, 3, 1
    v_mul_u32_u24 v46, 896, v46
    v_lshrrev_b32 v47, 4, v1
    v_lshl_add_u32 v46, v47, 2, v46
    buffer_load_dword v216, v46, s[52:55], s75 offen
    buffer_load_dword v217, v46, s[52:55], s75 offen offset:16
    s_add_u32 s36, s6, s74
    s_addc_u32 s37, s7, 0
    s_mov_b32 s38, s72
    s_mov_b32 s39, 0x20000
    s_barrier
    buffer_load_dwordx4 v[64:67], v2, s[36:39], 0 offen offset:0 nt
    buffer_load_dwordx4 v[68:71], v2, s[36:39], 0 offen offset:256 nt
    buffer_load_dwordx4 v[72:75], v2, s[36:39], 0 offen offset:2048 nt
    buffer_load_dwordx4 v[76:79], v2, s[36:39], 0 offen offset:2304 nt
    s_add_u32 s40, s8, s74
    s_addc_u32 s41, s9, 0
    s_mov_b32 s42, s72
    s_mov_b32 s43, 0x20000
    s_mov_b32 s44, s30
    s_mov_b32 s45, s31
    s_mov_b32 s46, 1048576
    s_mov_b32 s47, 0x20000
    v_and_b32 v44, 1, v1
    v_cmp_eq_u32 vcc, 1, v44
    v_mov_b32 v45, 0xffff
    v_mov_b32 v46, 0xffff0000
    v_cndmask_b32 v45, v45, v46, vcc
    v_bfe_u32 v44, v1, 1, 2
    v_cmp_eq_u32 vcc, 0, v44
    s_nop 1
    v_cndmask_b32 v4, 0, v45, vcc
    v_cmp_eq_u32 vcc, 1, v44
    s_nop 1
    v_cndmask_b32 v5, 0, v45, vcc
    v_cmp_eq_u32 vcc, 2, v44
    s_nop 1
    v_cndmask_b32 v6, 0, v45, vcc
    v_cmp_eq_u32 vcc, 3, v44
    s_nop 1
    v_cndmask_b32 v7, 0, v45, vcc
    s_mov_b32 s78, 0x01000100
    s_mov_b32 s79, 0x03020302
    v_bfe_u32 v45, v1, 3, 1
    v_cmp_eq_u32 vcc, 1, v45
    v_lshrrev_b32 v46, 5, v1
    v_lshlrev_b32 v46, 8, v46
    v_and_b32 v47, 7, v1
    v_lshl_add_u32 v46, v47, 5, v46
    v_bfe_u32 v47, v1, 4, 1
    v_lshl_add_u32 v46, v47, 4, v46
    s_lshl_b32 s75, s32, 9
    s_sub_u32 s75, s75, 512
    v_add_u32 v46, s75, v46
    s_waitcnt vmcnt(4)
    v_perm_b32 v44, v216, v216, s78
    v_and_b32 v8, v44, v4
    v_and_b32 v9, v44, v5
    v_and_b32 v10, v44, v6
    v_and_b32 v11, v44, v7
    s_nop 1
    v_mfma_f32_16x16x32_bf16 v[12:15], v[8:11], v[208:211], 0
    v_perm_b32 v44, v216, v216, s79
    v_and_b32 v8, v44, v4
    v_and_b32 v9, v44, v5
    v_and_b32 v10, v44, v6
    v_and_b32 v11, v44, v7
    s_nop 1
    v_mfma_f32_16x16x32_bf16 v[16:19], v[8:11], v[208:211], 0
    v_perm_b32 v44, v217, v217, s78
    v_and_b32 v8, v44, v4
    v_and_b32 v9, v44, v5
    v_and_b32 v10, v44, v6
    v_and_b32 v11, v44, v7
    s_nop 1
    v_mfma_f32_16x16x32_bf16 v[12:15], v[8:11], v[212:215], v[12:15]
    v_perm_b32 v44, v217, v217, s79
    v_and_b32 v8, v44, v4
    v_and_b32 v9, v44, v5
    v_and_b32 v10, v44, v6
    v_and_b32 v11, v44, v7
    s_nop 1
    v_mfma_f32_16x16x32_bf16 v[16:19], v[8:11], v[212:215], v[16:19]
    s_nop 7
    v_cndmask_b32 v12, v12, v16, vcc
    v_cndmask_b32 v13, v13, v17, vcc
    v_cndmask_b32 v14, v14, v18, vcc
    v_cndmask_b32 v15, v15, v19, vcc
    v_add_f32_dpp v12, v12, v12 row_ror:8 row_mask:0xf bank_mask:0xf
    v_add_f32_dpp v13, v13, v13 row_ror:8 row_mask:0xf bank_mask:0xf
    v_add_f32_dpp v14, v14, v14 row_ror:8 row_mask:0xf bank_mask:0xf
    v_add_f32_dpp v15, v15, v15 row_ror:8 row_mask:0xf bank_mask:0xf
    ds_write_b128 v46, v[12:15] offset:0
    s_waitcnt lgkmcnt(0)
    s_barrier
    s_branch L_krest
L_service:
    s_mov_b32 s60, s28
    s_mov_b32 s61, s29
    s_mov_b32 s62, 256
    s_mov_b32 s63, 0x20000
    v_mov_b32 v45, 0
    s_cmp_ge_u32 s2, 8
    s_cbranch_scc1 L_npoll
    s_or_b32 s101, s101, 0x80000000
    v_mov_b32 v56, s100
    v_mov_b32 v57, s101
    v_mov_b32 v58, 0
    v_mov_b32 v59, 0
    s_mov_b64 exec, 1
    buffer_atomic_cmpswap_x2 v[56:59], v45, s[60:63], 0 offen sc1
    s_mov_b64 exec, -1
L_npoll:
    buffer_load_dwordx2 v[48:49], v45, s[60:63], 0 offen sc1
    s_barrier
    s_sleep 8
    buffer_load_dwordx2 v[50:51], v45, s[60:63], 0 offen sc1
    s_sleep 8
    buffer_load_dwordx2 v[52:53], v45, s[60:63], 0 offen sc1
    s_sleep 8
    buffer_load_dwordx2 v[54:55], v45, s[60:63], 0 offen sc1
    s_mov_b32 s44, s30
    s_mov_b32 s45, s31
    s_mov_b32 s46, 1048576
    s_mov_b32 s47, 0x20000
    s_add_u32 s36, s6, s74
    s_addc_u32 s37, s7, 0
    s_mov_b32 s38, s72
    s_mov_b32 s39, 0x20000
    s_add_u32 s40, s8, s74
    s_addc_u32 s41, s9, 0
    s_mov_b32 s42, s72
    s_mov_b32 s43, 0x20000
    v_mov_b32 v208, -1
    v_mov_b32 v209, -1
    v_mov_b32 v210, -1
    v_mov_b32 v211, -1
    ds_write_b32 v45, v45 offset:4096
    v_lshlrev_b32 v46, 2, v1
    v_lshlrev_b32 v47, 4, v1
    ds_write_b32 v45, v45 offset:4240
    s_mov_b64 exec, 0x3ffff
    ds_write_b32 v46, v208 offset:4160
    s_mov_b64 exec, -1
    v_and_b32 v60, 1, v1
    v_cmp_eq_u32 vcc, 1, v60
    v_mov_b32 v61, 0xffff
    v_mov_b32 v62, 0xffff0000
    v_cndmask_b32 v61, v61, v62, vcc
    v_bfe_u32 v60, v1, 1, 2
    v_cmp_eq_u32 vcc, 0, v60
    s_nop 1
    v_cndmask_b32 v4, 0, v61, vcc
    v_cmp_eq_u32 vcc, 1, v60
    s_nop 1
    v_cndmask_b32 v5, 0, v61, vcc
    v_cmp_eq_u32 vcc, 2, v60
    s_nop 1
    v_cndmask_b32 v6, 0, v61, vcc
    v_cmp_eq_u32 vcc, 3, v60
    s_nop 1
    v_cndmask_b32 v7, 0, v61, vcc
    s_mov_b32 s72, 0
L_nloop:
    s_waitcnt vmcnt(3)
    v_readfirstlane_b32 s77, v49
    v_readfirstlane_b32 s76, v48
    s_cmp_lg_u32 s77, 0
    s_cbranch_scc1 L_nhave
    buffer_load_dwordx2 v[48:49], v45, s[60:63], 0 offen sc1
    s_waitcnt vmcnt(3)
    v_readfirstlane_b32 s77, v51
    v_readfirstlane_b32 s76, v50
    s_cmp_lg_u32 s77, 0
    s_cbranch_scc1 L_nhave
    buffer_load_dwordx2 v[50:51], v45, s[60:63], 0 offen sc1
    s_waitcnt vmcnt(3)
    v_readfirstlane_b32 s77, v53
    v_readfirstlane_b32 s76, v52
    s_cmp_lg_u32 s77, 0
    s_cbranch_scc1 L_nhave
    buffer_load_dwordx2 v[52:53], v45, s[60:63], 0 offen sc1
    s_waitcnt vmcnt(3)
    v_readfirstlane_b32 s77, v55
    v_readfirstlane_b32 s76, v54
    s_cmp_lg_u32 s77, 0
    s_cbranch_scc1 L_nhave
    buffer_load_dwordx2 v[54:55], v45, s[60:63], 0 offen sc1
    s_add_u32 s72, s72, 1
    s_cmp_lt_u32 s72, 65536
    s_cbranch_scc1 L_nloop
L_nhave:
    s_mul_i32 s10, s76, 0x9e3779b1
    s_xor_b32 s11, s77, s10
    s_lshr_b32 s6, s10, 22
    s_bfe_u32 s7, s10, 0xa000c
    s_bfe_u32 s8, s10, 0xa0002
    s_and_b32 s9, s77, 0xff
    s_lshl_b32 s9, s9, 2
    s_and_b32 s78, s10, 3
    s_or_b32 s9, s9, s78
    s_xor_b32 s9, s9, s6
    v_mov_b32 v56, s6
    v_mov_b32 v57, s7
    v_mov_b32 v58, s8
    v_mov_b32 v59, s9
    v_mov_b32 v60, s10
    v_mov_b32 v61, s11
    s_mov_b64 exec, 1
    ds_write_b128 v45, v[56:59] offset:4112
    ds_write_b64 v45, v[60:61] offset:4128
    s_mov_b64 exec, -1
    v_lshlrev_b32 v44, 4, v1
    s_add_u32 s75, s73, 1024
    s_waitcnt lgkmcnt(0)
    s_barrier
    s_mov_b32 exec_hi, 0
    ds_read_b128 v[208:211], v44 offset:0
    ds_read_b128 v[212:215], v44 offset:512
    ds_read_b128 v[216:219], v44 offset:1024
    ds_read_b128 v[220:223], v44 offset:1536
    ds_read_b128 v[224:227], v44 offset:2048
    ds_read_b128 v[228:231], v44 offset:2560
    ds_read_b128 v[232:235], v44 offset:3072
    s_waitcnt lgkmcnt(5)
    v_add_f32 v208, v208, v212
    v_add_f32 v209, v209, v213
    v_add_f32 v210, v210, v214
    v_add_f32 v211, v211, v215
    s_waitcnt lgkmcnt(3)
    v_add_f32 v216, v216, v220
    v_add_f32 v217, v217, v221
    v_add_f32 v218, v218, v222
    v_add_f32 v219, v219, v223
    s_waitcnt lgkmcnt(1)
    v_add_f32 v224, v224, v228
    v_add_f32 v225, v225, v229
    v_add_f32 v226, v226, v230
    v_add_f32 v227, v227, v231
    s_waitcnt lgkmcnt(0)
    v_add_f32 v208, v208, v216
    v_add_f32 v209, v209, v217
    v_add_f32 v210, v210, v218
    v_add_f32 v211, v211, v219
    v_add_f32 v224, v224, v232
    v_add_f32 v225, v225, v233
    v_add_f32 v226, v226, v234
    v_add_f32 v227, v227, v235
    v_add_f32 v208, v208, v224
    v_add_f32 v209, v209, v225
    v_add_f32 v210, v210, v226
    v_add_f32 v211, v211, v227
    v_bfi_b32 v208, v3, s6, v208
    v_bfi_b32 v209, v3, s7, v209
    v_bfi_b32 v210, v3, s8, v210
    v_bfi_b32 v211, v3, s9, v211
    buffer_store_dwordx4 v[208:211], v44, s[44:47], s75 offen sc1
    s_mov_b32 exec_hi, -1
    v_lshrrev_b32 v44, 4, v1
    v_and_b32 v45, 15, v1
    v_lshlrev_b32 v45, 4, v45
    v_lshl_add_u32 v44, v44, 16, v45
    s_lshl_b32 s75, s3, 12
    s_lshl_b32 s76, s34, 8
    s_add_u32 s75, s75, s76
    s_add_u32 s75, s75, 1024
    s_add_u32 s76, s75, 262144
    s_add_u32 s77, s75, 524288
    s_add_u32 s78, s75, 786432
    s_mov_b32 s72, 0
L_spin_1:
    buffer_load_dwordx4 v[224:227], v44, s[44:47], s75 offen sc1
    buffer_load_dwordx4 v[228:231], v44, s[44:47], s76 offen sc1
    buffer_load_dwordx4 v[232:235], v44, s[44:47], s77 offen sc1
    buffer_load_dwordx4 v[236:239], v44, s[44:47], s78 offen sc1
    s_waitcnt vmcnt(3)
    v_xor_b32 v224, s6, v224
    v_xor_b32 v225, s7, v225
    v_xor_b32 v226, s8, v226
    v_xor_b32 v227, s9, v227
    s_waitcnt vmcnt(2)
    v_xor_b32 v228, s6, v228
    v_xor_b32 v229, s7, v229
    v_xor_b32 v230, s8, v230
    v_xor_b32 v231, s9, v231
    s_waitcnt vmcnt(1)
    v_xor_b32 v232, s6, v232
    v_xor_b32 v233, s7, v233
    v_xor_b32 v234, s8, v234
    v_xor_b32 v235, s9, v235
    s_waitcnt vmcnt(0)
    v_xor_b32 v236, s6, v236
    v_xor_b32 v237, s7, v237
    v_xor_b32 v238, s8, v238
    v_xor_b32 v239, s9, v239
    v_or3_b32 v46, v224, v225, v226
    v_or3_b32 v46, v46, v227, v228
    v_or3_b32 v46, v46, v229, v230
    v_or3_b32 v46, v46, v231, v232
    v_or3_b32 v46, v46, v233, v234
    v_or3_b32 v46, v46, v235, v236
    v_or3_b32 v46, v46, v237, v238
    v_or_b32 v46, v46, v239
    v_and_b32 v46, v3, v46
    v_cmp_ne_u32 vcc, 0, v46
    s_cbranch_vccz L_done_2
    s_add_u32 s72, s72, 1
    s_cmp_lt_u32 s72, 65536
    s_cbranch_scc1 L_spin_1
L_done_2:
    v_permlane32_swap_b32 v224, v228
    v_permlane32_swap_b32 v232, v236
    v_permlane32_swap_b32 v225, v229
    v_permlane32_swap_b32 v233, v237
    v_permlane32_swap_b32 v226, v230
    v_permlane32_swap_b32 v234, v238
    v_permlane32_swap_b32 v227, v231
    v_permlane32_swap_b32 v235, v239
    v_add_f32 v224, v224, v228
    v_add_f32 v232, v232, v236
    v_add_f32 v225, v225, v229
    v_add_f32 v233, v233, v237
    v_add_f32 v226, v226, v230
    v_add_f32 v234, v234, v238
    v_add_f32 v227, v227, v231
    v_add_f32 v235, v235, v239
    v_permlane16_swap_b32 v224, v232
    v_permlane16_swap_b32 v225, v233
    v_permlane16_swap_b32 v226, v234
    v_permlane16_swap_b32 v227, v235
    v_add_f32 v224, v224, v232
    v_add_f32 v225, v225, v233
    v_add_f32 v226, v226, v234
    v_add_f32 v227, v227, v235
    v_cvt_pk_bf16_f32 v224, v224, v225
    v_cvt_pk_bf16_f32 v225, v226, v227
    v_bfe_u32 v45, v1, 4, 1
    v_lshlrev_b32 v45, 8, v45
    v_lshrrev_b32 v46, 5, v1
    v_lshl_add_u32 v45, v46, 7, v45
    v_and_b32 v46, 15, v1
    v_lshl_add_u32 v45, v46, 3, v45
    ds_write_b64 v45, v[224:225] offset:3584
    v_mov_b32 v46, 0
    v_mov_b32 v47, 1
    s_waitcnt lgkmcnt(0)
    ds_write_b32 v46, v47 offset:4096
    buffer_load_dwordx4 v[64:67], v2, s[36:39], 0 offen offset:0 nt
    buffer_load_dwordx4 v[68:71], v2, s[36:39], 0 offen offset:256 nt
    buffer_load_dwordx4 v[72:75], v2, s[36:39], 0 offen offset:2048 nt
    buffer_load_dwordx4 v[76:79], v2, s[36:39], 0 offen offset:2304 nt
L_krest:
    s_cmp_ge_u32 s32, 4
    s_cselect_b64 vcc, -1, 0
    s_cmp_eq_u32 s32, 0
    buffer_load_dwordx4 v[80:83], v2, s[36:39], s65 offen offset:0 nt
    s_cbranch_scc1 L_pk_4
    s_cbranch_vccnz L_pk_4
    s_waitcnt vmcnt(4)
L_pk_4:
    buffer_load_dwordx4 v[84:87], v2, s[36:39], s65 offen offset:256 nt
    s_and_b32 s77, s35, 3
    s_mul_i32 s77, s77, 112
    s_lshl_b32 s78, s32, 4
    s_add_u32 s77, s77, s78
    s_sub_u32 s77, s77, 16
    s_max_i32 s77, s77, 0
    s_mul_i32 s78, s77, 3584
    s_lshl_b32 s76, s14, 6
    s_add_u32 s76, s76, s78
    s_lshl_b32 s78, s77, 1
    s_add_u32 s48, s16, s76
    s_addc_u32 s49, s17, 0
    s_mov_b32 s50, 53824
    s_mov_b32 s51, 0x20000
    s_mov_b32 s52, s4
    s_mov_b32 s53, s5
    s_mov_b32 s54, 1792
    s_mov_b32 s55, 0x20000
    s_cmp_lt_u32 s14, 56
    s_cselect_b32 s50, s50, 0
    s_cmp_lg_u32 s32, 0
    s_cselect_b32 s50, s50, 0
    v_lshrrev_b32 v52, 2, v1
    v_and_b32 v53, 3, v1
    v_mul_u32_u24 v54, 3584, v52
    v_lshl_add_u32 v54, v53, 4, v54
    v_lshlrev_b32 v52, 1, v52
    buffer_load_dwordx4 v[252:255], v54, s[48:51], 0 offen nt
    s_cmp_ge_u32 s32, 4
    s_cselect_b64 vcc, -1, 0
    s_cmp_eq_u32 s32, 0
    s_cbranch_scc1 L_pk_5
    s_cbranch_vccnz L_pk_5
    s_waitcnt vmcnt(5)
L_pk_5:
    buffer_load_dwordx4 v[88:91], v2, s[36:39], s65 offen offset:2048 nt
    buffer_load_ushort v248, v52, s[52:55], s78 offen
    s_cmp_ge_u32 s32, 4
    s_cselect_b64 vcc, -1, 0
    s_cmp_eq_u32 s32, 0
    s_cbranch_scc1 L_pk_6
    s_waitcnt vmcnt(8)
    s_cbranch_vccnz L_pk_6
    s_waitcnt vmcnt(6)
L_pk_6:
    buffer_load_dwordx4 v[92:95], v2, s[36:39], s65 offen offset:2304 nt
    buffer_load_ushort v249, v52, s[52:55], s78 offen offset:896
    s_cmp_ge_u32 s32, 4
    s_cselect_b64 vcc, -1, 0
    s_cmp_eq_u32 s32, 0
    s_cbranch_scc1 L_pk_7
    s_waitcnt vmcnt(9)
    s_cbranch_vccnz L_pk_7
    s_waitcnt vmcnt(7)
L_pk_7:
    buffer_load_dwordx4 v[96:99], v2, s[36:39], s66 offen offset:0 nt
    s_cbranch_scc1 L_pk_8
    s_waitcnt vmcnt(9)
    s_cbranch_vccnz L_pk_8
    s_waitcnt vmcnt(7)
L_pk_8:
    buffer_load_dwordx4 v[100:103], v2, s[36:39], s66 offen offset:256 nt
    s_cbranch_scc1 L_pk_9
    s_waitcnt vmcnt(9)
    s_cbranch_vccnz L_pk_9
    s_waitcnt vmcnt(7)
L_pk_9:
    buffer_load_dwordx4 v[104:107], v2, s[36:39], s66 offen offset:2048 nt
    s_cmp_lt_u32 s32, 4
    s_cselect_b32 s79, -1, 0
    s_mul_i32 s75, s14, 57344
    s_add_u32 s48, s12, s75
    s_addc_u32 s49, s13, 0
    s_mov_b32 s50, 57344
    s_mov_b32 s51, 0x20000
    s_mov_b32 s52, s4
    s_mov_b32 s53, s5
    s_mov_b32 s54, 1792
    s_mov_b32 s55, 0x20000
    s_mov_b32 s56, s24
    s_mov_b32 s57, s25
    s_mov_b32 s58, 896
    s_mov_b32 s59, 0x20000
    s_and_b32 s50, s50, s79
    s_cmp_eq_u32 s32, 4
    s_cselect_b32 s54, s54, 0
    s_cselect_b32 s58, s58, 0
    v_lshrrev_b32 v46, 4, v1
    v_and_b32 v47, 15, v1
    v_lshlrev_b32 v47, 4, v47
    s_mul_i32 s75, s15, 256
    v_add_u32 v55, s75, v47
    v_mov_b32 v47, 0x40000000
    v_cmp_gt_u32 vcc, 0x380, v55
    s_nop 1
    v_cndmask_b32 v55, v47, v55, vcc
    s_and_b32 s75, s32, 3
    s_lshl_b32 s75, s75, 2
    v_add_u32 v48, s75, v46
    v_mul_u32_u24 v48, 3584, v48
    v_add_u32 v48, v48, v55
    v_lshlrev_b32 v57, 4, v1
    buffer_load_dwordx4 v[208:211], v48, s[48:51], 0 offen offset:0 nt
    s_cmp_ge_u32 s32, 4
    s_cselect_b64 vcc, -1, 0
    s_cmp_eq_u32 s32, 0
    s_cbranch_scc1 L_pk_10
    s_waitcnt vmcnt(10)
    s_cbranch_vccnz L_pk_10
    s_waitcnt vmcnt(7)
L_pk_10:
    buffer_load_dwordx4 v[108:111], v2, s[36:39], s66 offen offset:2304 nt
    buffer_load_dwordx4 v[212:215], v48, s[48:51], 0 offen offset:896 nt
    s_cmp_ge_u32 s32, 4
    s_cselect_b64 vcc, -1, 0
    s_cmp_eq_u32 s32, 0
    s_cbranch_scc1 L_pk_11
    s_waitcnt vmcnt(11)
    s_cbranch_vccnz L_pk_11
    s_waitcnt vmcnt(7)
L_pk_11:
    buffer_load_dwordx4 v[112:115], v2, s[36:39], s67 offen offset:0 nt
    buffer_load_dwordx4 v[216:219], v48, s[48:51], 0 offen offset:1792 nt
    s_cmp_ge_u32 s32, 4
    s_cselect_b64 vcc, -1, 0
    s_cmp_eq_u32 s32, 0
    s_cbranch_scc1 L_pk_12
    s_waitcnt vmcnt(11)
    s_cbranch_vccnz L_pk_12
    s_waitcnt vmcnt(7)
L_pk_12:
    buffer_load_dwordx4 v[116:119], v2, s[36:39], s67 offen offset:256 nt
    buffer_load_dwordx4 v[220:223], v48, s[48:51], 0 offen offset:2688 nt
    s_cmp_ge_u32 s32, 4
    s_cselect_b64 vcc, -1, 0
    s_cmp_eq_u32 s32, 0
    s_cbranch_scc1 L_pk_13
    s_waitcnt vmcnt(11)
    s_cbranch_vccnz L_pk_13
    s_waitcnt vmcnt(8)
L_pk_13:
    buffer_load_dwordx4 v[120:123], v2, s[36:39], s67 offen offset:2048 nt
    buffer_load_dwordx4 v[224:227], v57, s[52:55], 0 offen
    s_cmp_ge_u32 s32, 4
    s_cselect_b64 vcc, -1, 0
    s_cmp_eq_u32 s32, 0
    s_cbranch_scc1 L_pk_14
    s_waitcnt vmcnt(11)
    s_cbranch_vccnz L_pk_14
    s_waitcnt vmcnt(9)
L_pk_14:
    buffer_load_dwordx4 v[124:127], v2, s[36:39], s67 offen offset:2304 nt
    buffer_load_dwordx4 v[228:231], v57, s[52:55], 0 offen offset:896
    s_cmp_ge_u32 s32, 4
    s_cselect_b64 vcc, -1, 0
    s_cmp_eq_u32 s32, 0
    s_cbranch_scc1 L_pk_15
    s_waitcnt vmcnt(12)
    s_cbranch_vccnz L_pk_15
    s_waitcnt vmcnt(9)
L_pk_15:
    buffer_load_dwordx4 v[128:131], v2, s[36:39], s68 offen offset:0 nt
    buffer_load_dwordx4 v[232:235], v57, s[56:59], 0 offen
    s_cmp_ge_u32 s32, 4
    s_cselect_b64 vcc, -1, 0
    s_cmp_eq_u32 s32, 0
    s_cbranch_scc1 L_pk_16
    s_waitcnt vmcnt(13)
    s_cbranch_vccnz L_pk_16
    s_waitcnt vmcnt(9)
L_pk_16:
    buffer_load_dwordx4 v[132:135], v2, s[36:39], s68 offen offset:256 nt
    s_cmp_lt_u32 s14, 56
    s_cselect_b32 s79, s79, 0
    s_mul_i32 s75, s14, 28672
    s_add_u32 s48, s20, s75
    s_addc_u32 s49, s21, 0
    s_mov_b32 s50, 28672
    s_mov_b32 s51, 0x20000
    s_and_b32 s50, s50, s79
    v_mul_u32_u24 v46, 896, v46
    v_add_u32 v46, v46, v55
    s_and_b32 s75, s32, 3
    s_mul_i32 s75, s75, 7168
    buffer_load_dwordx4 v[236:239], v46, s[48:51], s75 offen nt
    s_cmp_ge_u32 s32, 4
    s_cselect_b64 vcc, -1, 0
    s_cmp_eq_u32 s32, 0
    s_cbranch_scc1 L_pk_17
    s_waitcnt vmcnt(13)
    s_cbranch_vccnz L_pk_17
    s_waitcnt vmcnt(9)
L_pk_17:
    buffer_load_dwordx4 v[136:139], v2, s[36:39], s68 offen offset:2048 nt
    buffer_load_dwordx4 v[240:243], v46, s[48:51], s75 offen offset:3584 nt
    s_cmp_ge_u32 s32, 4
    s_cselect_b64 vcc, -1, 0
    s_cmp_eq_u32 s32, 0
    s_waitcnt vmcnt(20)
    v_lshlrev_b32 v250, 16, v248
    v_lshlrev_b32 v251, 16, v249
    v_dot2_f32_bf16 v28, v252, v248, 0
    v_dot2_f32_bf16 v29, v252, v250, 0
    v_dot2_f32_bf16 v36, v252, v249, 0
    v_dot2_f32_bf16 v37, v252, v251, 0
    v_dot2_f32_bf16 v30, v253, v248, 0
    v_dot2_f32_bf16 v31, v253, v250, 0
    v_dot2_f32_bf16 v38, v253, v249, 0
    v_dot2_f32_bf16 v39, v253, v251, 0
    v_dot2_f32_bf16 v32, v254, v248, 0
    v_dot2_f32_bf16 v33, v254, v250, 0
    v_dot2_f32_bf16 v40, v254, v249, 0
    v_dot2_f32_bf16 v41, v254, v251, 0
    v_dot2_f32_bf16 v34, v255, v248, 0
    v_dot2_f32_bf16 v35, v255, v250, 0
    v_dot2_f32_bf16 v42, v255, v249, 0
    v_dot2_f32_bf16 v43, v255, v251, 0
    v_lshrrev_b32 v52, 5, v1
    v_lshlrev_b32 v52, 7, v52
    v_and_b32 v53, 3, v1
    v_lshl_add_u32 v52, v53, 5, v52
    v_bfe_u32 v54, v1, 4, 1
    v_lshl_add_u32 v62, v54, 4, v52
    s_lshl_b32 s75, s32, 8
    v_add_u32 v56, s75, v62
    v_permlane32_swap_b32 v28, v36
    v_permlane32_swap_b32 v29, v37
    v_permlane32_swap_b32 v30, v38
    v_permlane32_swap_b32 v31, v39
    v_permlane32_swap_b32 v32, v40
    v_permlane32_swap_b32 v33, v41
    v_permlane32_swap_b32 v34, v42
    v_permlane32_swap_b32 v35, v43
    v_add_f32 v28, v28, v36
    v_add_f32 v29, v29, v37
    v_add_f32 v30, v30, v38
    v_add_f32 v31, v31, v39
    v_add_f32 v32, v32, v40
    v_add_f32 v33, v33, v41
    v_add_f32 v34, v34, v42
    v_add_f32 v35, v35, v43
    v_permlane16_swap_b32 v28, v32
    v_permlane16_swap_b32 v29, v33
    v_permlane16_swap_b32 v30, v34
    v_permlane16_swap_b32 v31, v35
    v_add_f32 v28, v28, v32
    v_add_f32 v29, v29, v33
    v_add_f32 v30, v30, v34
    v_add_f32 v31, v31, v35
    v_add_f32_dpp v28, v28, v28 row_ror:4 row_mask:0xf bank_mask:0xf
    v_add_f32_dpp v29, v29, v29 row_ror:4 row_mask:0xf bank_mask:0xf
    v_add_f32_dpp v30, v30, v30 row_ror:4 row_mask:0xf bank_mask:0xf
    v_add_f32_dpp v31, v31, v31 row_ror:4 row_mask:0xf bank_mask:0xf
    v_add_f32_dpp v28, v28, v28 row_ror:8 row_mask:0xf bank_mask:0xf
    v_add_f32_dpp v29, v29, v29 row_ror:8 row_mask:0xf bank_mask:0xf
    v_add_f32_dpp v30, v30, v30 row_ror:8 row_mask:0xf bank_mask:0xf
    v_add_f32_dpp v31, v31, v31 row_ror:8 row_mask:0xf bank_mask:0xf
    ds_write_b128 v56, v[28:31] offset:4480
    v_mov_b32 v57, 1
    v_mov_b32 v58, 0
    s_waitcnt lgkmcnt(0)
    s_mov_b64 exec, 1
    ds_add_rtn_u32 v57, v58, v57 offset:4240
    s_mov_b64 exec, -1
    s_waitcnt lgkmcnt(0)
    v_readfirstlane_b32 s76, v57
    s_cmp_lg_u32 s76, 7
    s_cbranch_scc1 L_noh1_18
    ds_read_b128 v[56:59], v58 offset:4112
    ds_read_b128 v[164:167], v62 offset:4736
    ds_read_b128 v[168:171], v62 offset:4992
    ds_read_b128 v[172:175], v62 offset:5248
    ds_read_b128 v[176:179], v62 offset:5504
    ds_read_b128 v[180:183], v62 offset:5760
    ds_read_b128 v[184:187], v62 offset:6016
    ds_read_b128 v[188:191], v62 offset:6272
    s_add_u32 s76, s73, 1792
    s_waitcnt lgkmcnt(5)
    v_add_f32 v164, v164, v168
    v_add_f32 v165, v165, v169
    v_add_f32 v166, v166, v170
    v_add_f32 v167, v167, v171
    s_waitcnt lgkmcnt(3)
    v_add_f32 v172, v172, v176
    v_add_f32 v173, v173, v177
    v_add_f32 v174, v174, v178
    v_add_f32 v175, v175, v179
    s_waitcnt lgkmcnt(1)
    v_add_f32 v180, v180, v184
    v_add_f32 v181, v181, v185
    v_add_f32 v182, v182, v186
    v_add_f32 v183, v183, v187
    s_waitcnt lgkmcnt(0)
    v_add_f32 v164, v164, v188
    v_add_f32 v165, v165, v189
    v_add_f32 v166, v166, v190
    v_add_f32 v167, v167, v191
    v_add_f32 v172, v172, v180
    v_add_f32 v173, v173, v181
    v_add_f32 v174, v174, v182
    v_add_f32 v175, v175, v183
    v_add_f32 v164, v164, v172
    v_add_f32 v165, v165, v173
    v_add_f32 v166, v166, v174
    v_add_f32 v167, v167, v175
    v_bfi_b32 v164, v3, v56, v164
    v_bfi_b32 v165, v3, v57, v165
    v_bfi_b32 v166, v3, v58, v166
    v_bfi_b32 v167, v3, v59, v167
    s_mov_b32 exec_lo, 0x000f000f
    s_mov_b32 exec_hi, 0x000f000f
    buffer_store_dwordx4 v[164:167], v62, s[44:47], s76 offen sc1
    s_mov_b64 exec, -1
L_noh1_18:
    s_cmp_ge_u32 s32, 4
    s_cselect_b64 vcc, -1, 0
    s_cmp_eq_u32 s32, 0
    s_cbranch_scc1 L_pk_19
    s_waitcnt vmcnt(13)
    s_cbranch_vccnz L_pk_19
    s_waitcnt vmcnt(9)
L_pk_19:
    buffer_load_dwordx4 v[140:143], v2, s[36:39], s68 offen offset:2304 nt
    s_lshl_b32 s75, s14, 6
    s_add_u32 s56, s18, s75
    s_addc_u32 s57, s19, 0
    s_mov_b32 s58, 64
    s_mov_b32 s59, 0x20000
    s_and_b32 s58, s58, s79
    v_and_b32 v53, 3, v1
    v_bfe_u32 v54, v1, 4, 1
    v_lshlrev_b32 v53, 4, v53
    v_lshl_add_u32 v53, v54, 3, v53
    buffer_load_dwordx2 v[244:245], v53, s[56:59], 0 offen
    s_cmp_ge_u32 s32, 4
    s_cselect_b64 vcc, -1, 0
    s_cmp_eq_u32 s32, 0
    s_cbranch_scc1 L_pk_20
    s_waitcnt vmcnt(13)
    s_cbranch_vccnz L_pk_20
    s_waitcnt vmcnt(9)
L_pk_20:
    buffer_load_dwordx4 v[144:147], v2, s[36:39], s69 offen offset:0 nt
    s_mov_b32 s52, s22
    s_mov_b32 s53, s23
    s_mov_b32 s54, 896
    s_mov_b32 s55, 0x20000
    s_or_b32 s75, s14, s32
    s_cmp_eq_u32 s75, 0
    s_cselect_b32 s54, 896, 0
    v_lshl_add_u32 v54, v54, 3, v55
    buffer_load_dwordx2 v[246:247], v54, s[52:55], 0 offen
    s_cmp_ge_u32 s32, 4
    s_cselect_b64 vcc, -1, 0
    s_cmp_eq_u32 s32, 0
    s_cbranch_scc1 L_pk_21
    s_waitcnt vmcnt(13)
    s_cbranch_vccnz L_pk_21
    s_waitcnt vmcnt(9)
L_pk_21:
    buffer_load_dwordx4 v[148:151], v2, s[36:39], s69 offen offset:256 nt
    s_cbranch_scc1 L_pk_22
    s_waitcnt vmcnt(12)
    s_cbranch_vccnz L_pk_22
    s_waitcnt vmcnt(8)
L_pk_22:
    buffer_load_dwordx4 v[152:155], v2, s[36:39], s69 offen offset:2048 nt
    s_cbranch_scc1 L_pk_23
    s_waitcnt vmcnt(11)
    s_cbranch_vccnz L_pk_23
    s_waitcnt vmcnt(7)
L_pk_23:
    buffer_load_dwordx4 v[156:159], v2, s[36:39], s69 offen offset:2304 nt
    s_cbranch_scc1 L_pk_24
    s_waitcnt vmcnt(10)
    s_cbranch_vccnz L_pk_24
    s_waitcnt vmcnt(6)
L_pk_24:
    buffer_load_dwordx4 v[160:163], v2, s[36:39], s70 offen offset:0 nt
    s_cbranch_scc1 L_pk_25
    s_waitcnt vmcnt(9)
    s_cbranch_vccnz L_pk_25
    s_waitcnt vmcnt(5)
L_pk_25:
    buffer_load_dwordx4 v[164:167], v2, s[36:39], s70 offen offset:256 nt
    s_cbranch_scc1 L_pk_26
    s_waitcnt vmcnt(8)
    s_cbranch_vccnz L_pk_26
    s_waitcnt vmcnt(4)
L_pk_26:
    buffer_load_dwordx4 v[168:171], v2, s[36:39], s70 offen offset:2048 nt
    s_cbranch_scc1 L_pk_27
    s_waitcnt vmcnt(7)
    s_cbranch_vccnz L_pk_27
    s_waitcnt vmcnt(4)
L_pk_27:
    buffer_load_dwordx4 v[172:175], v2, s[36:39], s70 offen offset:2304 nt
    s_cbranch_scc1 L_pk_28
    s_waitcnt vmcnt(6)
    s_cbranch_vccnz L_pk_28
    s_waitcnt vmcnt(4)
L_pk_28:
    buffer_load_dwordx4 v[176:179], v2, s[36:39], s71 offen offset:0 nt
    s_cbranch_scc1 L_pk_29
    s_waitcnt vmcnt(6)
    s_cbranch_vccnz L_pk_29
    s_waitcnt vmcnt(4)
L_pk_29:
    buffer_load_dwordx4 v[180:183], v2, s[36:39], s71 offen offset:256 nt
    s_cbranch_scc1 L_pk_30
    s_waitcnt vmcnt(6)
    s_cbranch_vccnz L_pk_30
    s_waitcnt vmcnt(4)
L_pk_30:
    buffer_load_dwordx4 v[184:187], v2, s[36:39], s71 offen offset:2048 nt
    s_cbranch_scc1 L_pk_31
    s_waitcnt vmcnt(6)
    s_cbranch_vccnz L_pk_31
    s_waitcnt vmcnt(4)
L_pk_31:
    buffer_load_dwordx4 v[188:191], v2, s[36:39], s71 offen offset:2304 nt
    v_mov_b32 v46, 0
    s_mov_b32 s72, 0
L_spin_32:
    ds_read_b32 v47, v46 offset:4096
    s_waitcnt lgkmcnt(0)
    v_readfirstlane_b32 s76, v47
    s_cmp_eq_u32 s76, 1
    s_cbranch_scc1 L_done_33
    s_sleep 2
    s_add_u32 s72, s72, 1
    s_cmp_lt_u32 s72, 1048576
    s_cbranch_scc1 L_spin_32
L_done_33:
    v_and_b32 v44, 15, v1
    v_lshlrev_b32 v44, 4, v44
    ds_read_b128 v[20:23], v44 offset:3584
    ds_read_b128 v[24:27], v44 offset:3840
    s_waitcnt lgkmcnt(0)
    s_cmp_ge_u32 s32, 4
    s_waitcnt vmcnt(36)
    v_dot2_f32_bf16 v28, v64, v20, 0
    v_dot2_f32_bf16 v44, v68, v24, 0
    v_dot2_f32_bf16 v29, v72, v20, 0
    v_dot2_f32_bf16 v45, v76, v24, 0
    v_dot2_f32_bf16 v30, v80, v20, 0
    v_dot2_f32_bf16 v46, v84, v24, 0
    v_dot2_f32_bf16 v31, v88, v20, 0
    v_dot2_f32_bf16 v47, v92, v24, 0
    v_dot2_f32_bf16 v28, v65, v21, v28
    v_dot2_f32_bf16 v44, v69, v25, v44
    v_dot2_f32_bf16 v29, v73, v21, v29
    v_dot2_f32_bf16 v45, v77, v25, v45
    v_dot2_f32_bf16 v30, v81, v21, v30
    v_dot2_f32_bf16 v46, v85, v25, v46
    v_dot2_f32_bf16 v31, v89, v21, v31
    v_dot2_f32_bf16 v47, v93, v25, v47
    v_dot2_f32_bf16 v28, v66, v22, v28
    v_dot2_f32_bf16 v44, v70, v26, v44
    v_dot2_f32_bf16 v29, v74, v22, v29
    v_dot2_f32_bf16 v45, v78, v26, v45
    v_dot2_f32_bf16 v30, v82, v22, v30
    v_dot2_f32_bf16 v46, v86, v26, v46
    v_dot2_f32_bf16 v31, v90, v22, v31
    v_dot2_f32_bf16 v47, v94, v26, v47
    v_dot2_f32_bf16 v28, v67, v23, v28
    v_dot2_f32_bf16 v44, v71, v27, v44
    v_dot2_f32_bf16 v29, v75, v23, v29
    v_dot2_f32_bf16 v45, v79, v27, v45
    v_dot2_f32_bf16 v30, v83, v23, v30
    v_dot2_f32_bf16 v46, v87, v27, v46
    v_dot2_f32_bf16 v31, v91, v23, v31
    v_dot2_f32_bf16 v47, v95, v27, v47
    s_cbranch_scc1 L_pk_34
    s_waitcnt vmcnt(7)
L_pk_34:
    buffer_load_dwordx4 v[64:67], v2, s[40:43], 0 offen offset:0 nt
    s_cbranch_scc1 L_pk_35
    s_waitcnt vmcnt(7)
L_pk_35:
    buffer_load_dwordx4 v[68:71], v2, s[40:43], 0 offen offset:256 nt
    s_cbranch_scc1 L_pk_36
    s_waitcnt vmcnt(7)
L_pk_36:
    buffer_load_dwordx4 v[72:75], v2, s[40:43], 0 offen offset:2048 nt
    s_cbranch_scc1 L_pk_37
    s_waitcnt vmcnt(7)
L_pk_37:
    buffer_load_dwordx4 v[76:79], v2, s[40:43], 0 offen offset:2304 nt
    s_cbranch_scc1 L_pk_38
    s_waitcnt vmcnt(7)
L_pk_38:
    buffer_load_dwordx4 v[80:83], v2, s[40:43], s65 offen offset:0 nt
    s_cbranch_scc1 L_pk_39
    s_waitcnt vmcnt(7)
L_pk_39:
    buffer_load_dwordx4 v[84:87], v2, s[40:43], s65 offen offset:256 nt
    s_cbranch_scc1 L_pk_40
    s_waitcnt vmcnt(7)
L_pk_40:
    buffer_load_dwordx4 v[88:91], v2, s[40:43], s65 offen offset:2048 nt
    s_cbranch_scc1 L_pk_41
    s_waitcnt vmcnt(7)
L_pk_41:
    buffer_load_dwordx4 v[92:95], v2, s[40:43], s65 offen offset:2304 nt
    v_add_f32 v28, v28, v44
    v_add_f32 v29, v29, v45
    v_add_f32 v30, v30, v46
    v_add_f32 v31, v31, v47
    v_add_f32_dpp v28, v28, v28 row_ror:8 row_mask:0xf bank_mask:0xf
    v_add_f32_dpp v29, v29, v29 row_ror:8 row_mask:0xf bank_mask:0xf
    v_add_f32_dpp v30, v30, v30 row_ror:8 row_mask:0xf bank_mask:0xf
    v_add_f32_dpp v31, v31, v31 row_ror:8 row_mask:0xf bank_mask:0xf
    v_add_f32_dpp v28, v28, v28 row_ror:4 row_mask:0xf bank_mask:0xf
    v_add_f32_dpp v29, v29, v29 row_ror:4 row_mask:0xf bank_mask:0xf
    v_add_f32_dpp v30, v30, v30 row_ror:4 row_mask:0xf bank_mask:0xf
    v_add_f32_dpp v31, v31, v31 row_ror:4 row_mask:0xf bank_mask:0xf
    v_add_f32_dpp v28, v28, v28 row_ror:2 row_mask:0xf bank_mask:0xf
    v_add_f32_dpp v29, v29, v29 row_ror:2 row_mask:0xf bank_mask:0xf
    v_add_f32_dpp v30, v30, v30 row_ror:2 row_mask:0xf bank_mask:0xf
    v_add_f32_dpp v31, v31, v31 row_ror:2 row_mask:0xf bank_mask:0xf
    v_add_f32_dpp v28, v28, v28 row_ror:1 row_mask:0xf bank_mask:0xf
    v_add_f32_dpp v29, v29, v29 row_ror:1 row_mask:0xf bank_mask:0xf
    v_add_f32_dpp v30, v30, v30 row_ror:1 row_mask:0xf bank_mask:0xf
    v_add_f32_dpp v31, v31, v31 row_ror:1 row_mask:0xf bank_mask:0xf
    s_waitcnt vmcnt(30)
    v_dot2_f32_bf16 v32, v96, v20, 0
    v_dot2_f32_bf16 v44, v100, v24, 0
    v_dot2_f32_bf16 v33, v104, v20, 0
    v_dot2_f32_bf16 v45, v108, v24, 0
    v_dot2_f32_bf16 v34, v112, v20, 0
    v_dot2_f32_bf16 v46, v116, v24, 0
    v_dot2_f32_bf16 v35, v120, v20, 0
    v_dot2_f32_bf16 v47, v124, v24, 0
    v_dot2_f32_bf16 v32, v97, v21, v32
    v_dot2_f32_bf16 v44, v101, v25, v44
    v_dot2_f32_bf16 v33, v105, v21, v33
    v_dot2_f32_bf16 v45, v109, v25, v45
    v_dot2_f32_bf16 v34, v113, v21, v34
    v_dot2_f32_bf16 v46, v117, v25, v46
    v_dot2_f32_bf16 v35, v121, v21, v35
    v_dot2_f32_bf16 v47, v125, v25, v47
    v_dot2_f32_bf16 v32, v98, v22, v32
    v_dot2_f32_bf16 v44, v102, v26, v44
    v_dot2_f32_bf16 v33, v106, v22, v33
    v_dot2_f32_bf16 v45, v110, v26, v45
    v_dot2_f32_bf16 v34, v114, v22, v34
    v_dot2_f32_bf16 v46, v118, v26, v46
    v_dot2_f32_bf16 v35, v122, v22, v35
    v_dot2_f32_bf16 v47, v126, v26, v47
    v_dot2_f32_bf16 v32, v99, v23, v32
    v_dot2_f32_bf16 v44, v103, v27, v44
    v_dot2_f32_bf16 v33, v107, v23, v33
    v_dot2_f32_bf16 v45, v111, v27, v45
    v_dot2_f32_bf16 v34, v115, v23, v34
    v_dot2_f32_bf16 v46, v119, v27, v46
    v_dot2_f32_bf16 v35, v123, v23, v35
    v_dot2_f32_bf16 v47, v127, v27, v47
    s_cbranch_scc1 L_pk_42
    s_waitcnt vmcnt(7)
L_pk_42:
    buffer_load_dwordx4 v[96:99], v2, s[40:43], s66 offen offset:0 nt
    s_cbranch_scc1 L_pk_43
    s_waitcnt vmcnt(7)
L_pk_43:
    buffer_load_dwordx4 v[100:103], v2, s[40:43], s66 offen offset:256 nt
    v_add_f32 v32, v32, v44
    v_add_f32 v33, v33, v45
    v_add_f32 v34, v34, v46
    v_add_f32 v35, v35, v47
    v_add_f32_dpp v32, v32, v32 row_ror:8 row_mask:0xf bank_mask:0xf
    v_add_f32_dpp v33, v33, v33 row_ror:8 row_mask:0xf bank_mask:0xf
    v_add_f32_dpp v34, v34, v34 row_ror:8 row_mask:0xf bank_mask:0xf
    v_add_f32_dpp v35, v35, v35 row_ror:8 row_mask:0xf bank_mask:0xf
    v_add_f32_dpp v32, v32, v32 row_ror:4 row_mask:0xf bank_mask:0xf
    v_add_f32_dpp v33, v33, v33 row_ror:4 row_mask:0xf bank_mask:0xf
    v_add_f32_dpp v34, v34, v34 row_ror:4 row_mask:0xf bank_mask:0xf
    v_add_f32_dpp v35, v35, v35 row_ror:4 row_mask:0xf bank_mask:0xf
    v_add_f32_dpp v32, v32, v32 row_ror:2 row_mask:0xf bank_mask:0xf
    v_add_f32_dpp v33, v33, v33 row_ror:2 row_mask:0xf bank_mask:0xf
    v_add_f32_dpp v34, v34, v34 row_ror:2 row_mask:0xf bank_mask:0xf
    v_add_f32_dpp v35, v35, v35 row_ror:2 row_mask:0xf bank_mask:0xf
    v_add_f32_dpp v32, v32, v32 row_ror:1 row_mask:0xf bank_mask:0xf
    v_add_f32_dpp v33, v33, v33 row_ror:1 row_mask:0xf bank_mask:0xf
    v_add_f32_dpp v34, v34, v34 row_ror:1 row_mask:0xf bank_mask:0xf
    v_add_f32_dpp v35, v35, v35 row_ror:1 row_mask:0xf bank_mask:0xf
    s_waitcnt vmcnt(18)
    v_dot2_f32_bf16 v36, v128, v20, 0
    v_dot2_f32_bf16 v44, v132, v24, 0
    v_dot2_f32_bf16 v37, v136, v20, 0
    v_dot2_f32_bf16 v45, v140, v24, 0
    v_dot2_f32_bf16 v38, v144, v20, 0
    v_dot2_f32_bf16 v46, v148, v24, 0
    v_dot2_f32_bf16 v39, v152, v20, 0
    v_dot2_f32_bf16 v47, v156, v24, 0
    v_dot2_f32_bf16 v36, v129, v21, v36
    v_dot2_f32_bf16 v44, v133, v25, v44
    v_dot2_f32_bf16 v37, v137, v21, v37
    v_dot2_f32_bf16 v45, v141, v25, v45
    v_dot2_f32_bf16 v38, v145, v21, v38
    v_dot2_f32_bf16 v46, v149, v25, v46
    v_dot2_f32_bf16 v39, v153, v21, v39
    v_dot2_f32_bf16 v47, v157, v25, v47
    v_dot2_f32_bf16 v36, v130, v22, v36
    v_dot2_f32_bf16 v44, v134, v26, v44
    v_dot2_f32_bf16 v37, v138, v22, v37
    v_dot2_f32_bf16 v45, v142, v26, v45
    v_dot2_f32_bf16 v38, v146, v22, v38
    v_dot2_f32_bf16 v46, v150, v26, v46
    v_dot2_f32_bf16 v39, v154, v22, v39
    v_dot2_f32_bf16 v47, v158, v26, v47
    v_dot2_f32_bf16 v36, v131, v23, v36
    v_dot2_f32_bf16 v44, v135, v27, v44
    v_dot2_f32_bf16 v37, v139, v23, v37
    v_dot2_f32_bf16 v45, v143, v27, v45
    v_dot2_f32_bf16 v38, v147, v23, v38
    v_dot2_f32_bf16 v46, v151, v27, v46
    v_dot2_f32_bf16 v39, v155, v23, v39
    v_dot2_f32_bf16 v47, v159, v27, v47
    v_add_f32 v36, v36, v44
    v_add_f32 v37, v37, v45
    v_add_f32 v38, v38, v46
    v_add_f32 v39, v39, v47
    v_add_f32_dpp v36, v36, v36 row_ror:8 row_mask:0xf bank_mask:0xf
    v_add_f32_dpp v37, v37, v37 row_ror:8 row_mask:0xf bank_mask:0xf
    v_add_f32_dpp v38, v38, v38 row_ror:8 row_mask:0xf bank_mask:0xf
    v_add_f32_dpp v39, v39, v39 row_ror:8 row_mask:0xf bank_mask:0xf
    v_add_f32_dpp v36, v36, v36 row_ror:4 row_mask:0xf bank_mask:0xf
    v_add_f32_dpp v37, v37, v37 row_ror:4 row_mask:0xf bank_mask:0xf
    v_add_f32_dpp v38, v38, v38 row_ror:4 row_mask:0xf bank_mask:0xf
    v_add_f32_dpp v39, v39, v39 row_ror:4 row_mask:0xf bank_mask:0xf
    v_add_f32_dpp v36, v36, v36 row_ror:2 row_mask:0xf bank_mask:0xf
    v_add_f32_dpp v37, v37, v37 row_ror:2 row_mask:0xf bank_mask:0xf
    v_add_f32_dpp v38, v38, v38 row_ror:2 row_mask:0xf bank_mask:0xf
    v_add_f32_dpp v39, v39, v39 row_ror:2 row_mask:0xf bank_mask:0xf
    v_add_f32_dpp v36, v36, v36 row_ror:1 row_mask:0xf bank_mask:0xf
    v_add_f32_dpp v37, v37, v37 row_ror:1 row_mask:0xf bank_mask:0xf
    v_add_f32_dpp v38, v38, v38 row_ror:1 row_mask:0xf bank_mask:0xf
    v_add_f32_dpp v39, v39, v39 row_ror:1 row_mask:0xf bank_mask:0xf
    s_waitcnt vmcnt(10)
    v_dot2_f32_bf16 v40, v160, v20, 0
    v_dot2_f32_bf16 v44, v164, v24, 0
    v_dot2_f32_bf16 v41, v168, v20, 0
    v_dot2_f32_bf16 v45, v172, v24, 0
    v_dot2_f32_bf16 v42, v176, v20, 0
    v_dot2_f32_bf16 v46, v180, v24, 0
    v_dot2_f32_bf16 v43, v184, v20, 0
    v_dot2_f32_bf16 v47, v188, v24, 0
    v_dot2_f32_bf16 v40, v161, v21, v40
    v_dot2_f32_bf16 v44, v165, v25, v44
    v_dot2_f32_bf16 v41, v169, v21, v41
    v_dot2_f32_bf16 v45, v173, v25, v45
    v_dot2_f32_bf16 v42, v177, v21, v42
    v_dot2_f32_bf16 v46, v181, v25, v46
    v_dot2_f32_bf16 v43, v185, v21, v43
    v_dot2_f32_bf16 v47, v189, v25, v47
    v_dot2_f32_bf16 v40, v162, v22, v40
    v_dot2_f32_bf16 v44, v166, v26, v44
    v_dot2_f32_bf16 v41, v170, v22, v41
    v_dot2_f32_bf16 v45, v174, v26, v45
    v_dot2_f32_bf16 v42, v178, v22, v42
    v_dot2_f32_bf16 v46, v182, v26, v46
    v_dot2_f32_bf16 v43, v186, v22, v43
    v_dot2_f32_bf16 v47, v190, v26, v47
    v_dot2_f32_bf16 v40, v163, v23, v40
    v_dot2_f32_bf16 v44, v167, v27, v44
    v_dot2_f32_bf16 v41, v171, v23, v41
    v_dot2_f32_bf16 v45, v175, v27, v45
    v_dot2_f32_bf16 v42, v179, v23, v42
    v_dot2_f32_bf16 v46, v183, v27, v46
    v_dot2_f32_bf16 v43, v187, v23, v43
    v_dot2_f32_bf16 v47, v191, v27, v47
    v_add_f32 v40, v40, v44
    v_add_f32 v41, v41, v45
    v_add_f32 v42, v42, v46
    v_add_f32 v43, v43, v47
    v_add_f32_dpp v40, v40, v40 row_ror:8 row_mask:0xf bank_mask:0xf
    v_add_f32_dpp v41, v41, v41 row_ror:8 row_mask:0xf bank_mask:0xf
    v_add_f32_dpp v42, v42, v42 row_ror:8 row_mask:0xf bank_mask:0xf
    v_add_f32_dpp v43, v43, v43 row_ror:8 row_mask:0xf bank_mask:0xf
    v_add_f32_dpp v40, v40, v40 row_ror:4 row_mask:0xf bank_mask:0xf
    v_add_f32_dpp v41, v41, v41 row_ror:4 row_mask:0xf bank_mask:0xf
    v_add_f32_dpp v42, v42, v42 row_ror:4 row_mask:0xf bank_mask:0xf
    v_add_f32_dpp v43, v43, v43 row_ror:4 row_mask:0xf bank_mask:0xf
    v_add_f32_dpp v40, v40, v40 row_ror:2 row_mask:0xf bank_mask:0xf
    v_add_f32_dpp v41, v41, v41 row_ror:2 row_mask:0xf bank_mask:0xf
    v_add_f32_dpp v42, v42, v42 row_ror:2 row_mask:0xf bank_mask:0xf
    v_add_f32_dpp v43, v43, v43 row_ror:2 row_mask:0xf bank_mask:0xf
    v_add_f32_dpp v40, v40, v40 row_ror:1 row_mask:0xf bank_mask:0xf
    v_add_f32_dpp v41, v41, v41 row_ror:1 row_mask:0xf bank_mask:0xf
    v_add_f32_dpp v42, v42, v42 row_ror:1 row_mask:0xf bank_mask:0xf
    v_add_f32_dpp v43, v43, v43 row_ror:1 row_mask:0xf bank_mask:0xf
    v_max3_f32 v44, v28, v32, v36
    v_max3_f32 v45, v29, v33, v37
    v_max3_f32 v46, v30, v34, v38
    v_max3_f32 v47, v31, v35, v39
    v_max_f32 v44, v44, v40
    v_max_f32 v45, v45, v41
    v_max_f32 v46, v46, v42
    v_max_f32 v47, v47, v43
    v_max3_f32 v44, v44, v45, v46
    v_max_f32 v44, v44, v47
    v_mov_b32 v45, v44
    s_nop 1
    v_permlane32_swap_b32 v44, v45
    v_max_f32 v44, v44, v45
    v_mov_b32 v45, v44
    s_nop 1
    v_permlane16_swap_b32 v44, v45
    v_max_f32 v44, v44, v45
    s_mov_b32 s75, 0x3db8aa3b
    v_mul_f32 v58, s75, v44
    v_fma_f32 v28, v28, s75, -v58
    v_fma_f32 v29, v29, s75, -v58
    v_fma_f32 v30, v30, s75, -v58
    v_fma_f32 v31, v31, s75, -v58
    v_fma_f32 v32, v32, s75, -v58
    v_fma_f32 v33, v33, s75, -v58
    v_fma_f32 v34, v34, s75, -v58
    v_fma_f32 v35, v35, s75, -v58
    v_fma_f32 v36, v36, s75, -v58
    v_fma_f32 v37, v37, s75, -v58
    v_fma_f32 v38, v38, s75, -v58
    v_fma_f32 v39, v39, s75, -v58
    v_fma_f32 v40, v40, s75, -v58
    v_fma_f32 v41, v41, s75, -v58
    v_fma_f32 v42, v42, s75, -v58
    v_fma_f32 v43, v43, s75, -v58
    v_exp_f32 v28, v28
    v_exp_f32 v29, v29
    v_exp_f32 v30, v30
    v_exp_f32 v31, v31
    v_exp_f32 v32, v32
    v_exp_f32 v33, v33
    v_exp_f32 v34, v34
    v_exp_f32 v35, v35
    v_exp_f32 v36, v36
    v_exp_f32 v37, v37
    v_exp_f32 v38, v38
    v_exp_f32 v39, v39
    v_exp_f32 v40, v40
    v_exp_f32 v41, v41
    v_exp_f32 v42, v42
    v_exp_f32 v43, v43
    v_cvt_pk_bf16_f32 v28, v28, v28
    v_cvt_pk_bf16_f32 v29, v29, v29
    v_cvt_pk_bf16_f32 v30, v30, v30
    v_cvt_pk_bf16_f32 v31, v31, v31
    v_cvt_pk_bf16_f32 v32, v32, v32
    v_cvt_pk_bf16_f32 v33, v33, v33
    v_cvt_pk_bf16_f32 v34, v34, v34
    v_cvt_pk_bf16_f32 v35, v35, v35
    v_cvt_pk_bf16_f32 v36, v36, v36
    v_cvt_pk_bf16_f32 v37, v37, v37
    v_cvt_pk_bf16_f32 v38, v38, v38
    v_cvt_pk_bf16_f32 v39, v39, v39
    v_cvt_pk_bf16_f32 v40, v40, v40
    v_cvt_pk_bf16_f32 v41, v41, v41
    v_cvt_pk_bf16_f32 v42, v42, v42
    v_cvt_pk_bf16_f32 v43, v43, v43
    v_mov_b32 v60, 0x3f80
    v_dot2_f32_bf16 v59, v28, v60, 0
    v_dot2_f32_bf16 v61, v29, v60, 0
    v_dot2_f32_bf16 v59, v30, v60, v59
    v_dot2_f32_bf16 v61, v31, v60, v61
    v_dot2_f32_bf16 v59, v32, v60, v59
    v_dot2_f32_bf16 v61, v33, v60, v61
    v_dot2_f32_bf16 v59, v34, v60, v59
    v_dot2_f32_bf16 v61, v35, v60, v61
    v_dot2_f32_bf16 v59, v36, v60, v59
    v_dot2_f32_bf16 v61, v37, v60, v61
    v_dot2_f32_bf16 v59, v38, v60, v59
    v_dot2_f32_bf16 v61, v39, v60, v61
    v_dot2_f32_bf16 v59, v40, v60, v59
    v_dot2_f32_bf16 v61, v41, v60, v61
    v_dot2_f32_bf16 v59, v42, v60, v59
    v_dot2_f32_bf16 v61, v43, v60, v61
    s_nop 2
    v_add_f32 v59, v59, v61
    v_mov_b32 v45, v59
    s_nop 1
    v_permlane32_swap_b32 v59, v45
    v_add_f32 v59, v59, v45
    v_mov_b32 v45, v59
    s_nop 1
    v_permlane16_swap_b32 v59, v45
    v_add_f32 v59, v59, v45
    s_lshl_b32 s75, s32, 3
    v_mov_b32 v46, s75
    ds_write_b64 v46, v[58:59] offset:4160
    s_cmp_lg_u32 s32, 4
    s_cbranch_scc1 L_nogate_44
    v_dot2_f32_bf16 v46, v224, v232, 0
    v_dot2_f32_bf16 v46, v225, v233, v46
    v_dot2_f32_bf16 v46, v226, v234, v46
    v_dot2_f32_bf16 v46, v227, v235, v46
    v_dot2_f32_bf16 v47, v228, v232, 0
    v_dot2_f32_bf16 v47, v229, v233, v47
    v_dot2_f32_bf16 v47, v230, v234, v47
    v_dot2_f32_bf16 v47, v231, v235, v47
    s_nop 2
    v_permlane32_swap_b32 v46, v47
    v_add_f32 v46, v46, v47
    s_nop 1
    v_add_f32_dpp v46, v46, v46 row_ror:8 row_mask:0xf bank_mask:0xf
    s_nop 1
    v_add_f32_dpp v46, v46, v46 row_ror:4 row_mask:0xf bank_mask:0xf
    s_nop 1
    v_add_f32_dpp v46, v46, v46 row_ror:2 row_mask:0xf bank_mask:0xf
    s_nop 1
    v_add_f32_dpp v46, v46, v46 row_ror:1 row_mask:0xf bank_mask:0xf
    v_mov_b32 v47, v46
    s_nop 1
    v_permlane16_swap_b32 v46, v47
    v_add_f32 v46, v46, v47
    v_mul_f32 v46, 0xbfb8aa3b, v46
    v_exp_f32 v46, v46
    s_nop 0
    v_add_f32 v46, 1.0, v46
    v_rcp_f32 v46, v46
    v_lshrrev_b32 v47, 5, v1
    v_lshlrev_b32 v47, 2, v47
    ds_write_b32 v47, v46 offset:4224
L_nogate_44:
    s_cmp_ge_u32 s32, 4
    v_and_b32 v8, v28, v4
    v_and_b32 v9, v28, v5
    v_and_b32 v10, v28, v6
    v_and_b32 v11, v28, v7
    s_waitcnt vmcnt(9)
    s_nop 0
    v_mfma_f32_16x16x32_bf16 v[12:15], v[8:11], v[64:67], 0
    s_waitcnt vmcnt(8)
    v_mfma_f32_16x16x32_bf16 v[16:19], v[8:11], v[68:71], 0
    s_cbranch_scc1 L_pk_45
    s_waitcnt vmcnt(7)
L_pk_45:
    buffer_load_dwordx4 v[104:107], v2, s[40:43], s66 offen offset:2048 nt
    s_cbranch_scc1 L_pk_46
    s_waitcnt vmcnt(7)
L_pk_46:
    buffer_load_dwordx4 v[108:111], v2, s[40:43], s66 offen offset:2304 nt
    v_and_b32 v8, v29, v4
    v_and_b32 v9, v29, v5
    v_and_b32 v10, v29, v6
    v_and_b32 v11, v29, v7
    s_waitcnt vmcnt(9)
    s_nop 0
    v_mfma_f32_16x16x32_bf16 v[12:15], v[8:11], v[72:75], v[12:15]
    s_waitcnt vmcnt(8)
    v_mfma_f32_16x16x32_bf16 v[16:19], v[8:11], v[76:79], v[16:19]
    s_cbranch_scc1 L_pk_47
    s_waitcnt vmcnt(7)
L_pk_47:
    buffer_load_dwordx4 v[112:115], v2, s[40:43], s67 offen offset:0 nt
    s_cbranch_scc1 L_pk_48
    s_waitcnt vmcnt(7)
L_pk_48:
    buffer_load_dwordx4 v[116:119], v2, s[40:43], s67 offen offset:256 nt
    v_and_b32 v8, v30, v4
    v_and_b32 v9, v30, v5
    v_and_b32 v10, v30, v6
    v_and_b32 v11, v30, v7
    s_waitcnt vmcnt(9)
    s_nop 0
    v_mfma_f32_16x16x32_bf16 v[12:15], v[8:11], v[80:83], v[12:15]
    s_waitcnt vmcnt(8)
    v_mfma_f32_16x16x32_bf16 v[16:19], v[8:11], v[84:87], v[16:19]
    s_cbranch_scc1 L_pk_49
    s_waitcnt vmcnt(7)
L_pk_49:
    buffer_load_dwordx4 v[120:123], v2, s[40:43], s67 offen offset:2048 nt
    s_cbranch_scc1 L_pk_50
    s_waitcnt vmcnt(7)
L_pk_50:
    buffer_load_dwordx4 v[124:127], v2, s[40:43], s67 offen offset:2304 nt
    v_and_b32 v8, v31, v4
    v_and_b32 v9, v31, v5
    v_and_b32 v10, v31, v6
    v_and_b32 v11, v31, v7
    s_waitcnt vmcnt(9)
    s_nop 0
    v_mfma_f32_16x16x32_bf16 v[12:15], v[8:11], v[88:91], v[12:15]
    s_waitcnt vmcnt(8)
    v_mfma_f32_16x16x32_bf16 v[16:19], v[8:11], v[92:95], v[16:19]
    s_cbranch_scc1 L_pk_51
    s_waitcnt vmcnt(7)
L_pk_51:
    buffer_load_dwordx4 v[128:131], v2, s[40:43], s68 offen offset:0 nt
    s_cbranch_scc1 L_pk_52
    s_waitcnt vmcnt(7)
L_pk_52:
    buffer_load_dwordx4 v[132:135], v2, s[40:43], s68 offen offset:256 nt
    v_bfe_u32 v68, v1, 2, 2
    v_lshl_add_u32 v68, v68, 16, v62
    s_and_b32 s75, s35, 12
    s_lshl_b32 s75, s75, 16
    s_lshl_b32 s76, s33, 12
    s_add_u32 s75, s75, s76
    s_add_u32 s22, s75, 1792
    s_mov_b32 s48, s30
    s_mov_b32 s49, s31
    s_mov_b32 s50, 1048576
    s_mov_b32 s51, 0x20000
    s_cmp_lt_u32 s32, 4
    s_cselect_b32 s50, s50, 0
    buffer_load_dwordx4 v[64:67], v68, s[48:51], s22 offen sc1
    s_cmp_ge_u32 s32, 4
    v_and_b32 v8, v32, v4
    v_and_b32 v9, v32, v5
    v_and_b32 v10, v32, v6
    v_and_b32 v11, v32, v7
    s_waitcnt vmcnt(10)
    s_nop 0
    v_mfma_f32_16x16x32_bf16 v[12:15], v[8:11], v[96:99], v[12:15]
    s_waitcnt vmcnt(9)
    v_mfma_f32_16x16x32_bf16 v[16:19], v[8:11], v[100:103], v[16:19]
    s_cbranch_scc1 L_pk_53
    s_waitcnt vmcnt(8)
L_pk_53:
    buffer_load_dwordx4 v[136:139], v2, s[40:43], s68 offen offset:2048 nt
    s_cbranch_scc1 L_pk_54
    s_waitcnt vmcnt(8)
L_pk_54:
    buffer_load_dwordx4 v[140:143], v2, s[40:43], s68 offen offset:2304 nt
    v_and_b32 v8, v33, v4
    v_and_b32 v9, v33, v5
    v_and_b32 v10, v33, v6
    v_and_b32 v11, v33, v7
    s_waitcnt vmcnt(10)
    s_nop 0
    v_mfma_f32_16x16x32_bf16 v[12:15], v[8:11], v[104:107], v[12:15]
    s_waitcnt vmcnt(9)
    v_mfma_f32_16x16x32_bf16 v[16:19], v[8:11], v[108:111], v[16:19]
    s_cbranch_scc1 L_pk_55
    s_waitcnt vmcnt(8)
L_pk_55:
    buffer_load_dwordx4 v[144:147], v2, s[40:43], s69 offen offset:0 nt
    s_cbranch_scc1 L_pk_56
    s_waitcnt vmcnt(8)
L_pk_56:
    buffer_load_dwordx4 v[148:151], v2, s[40:43], s69 offen offset:256 nt
    v_and_b32 v8, v34, v4
    v_and_b32 v9, v34, v5
    v_and_b32 v10, v34, v6
    v_and_b32 v11, v34, v7
    s_waitcnt vmcnt(10)
    s_nop 0
    v_mfma_f32_16x16x32_bf16 v[12:15], v[8:11], v[112:115], v[12:15]
    s_waitcnt vmcnt(9)
    v_mfma_f32_16x16x32_bf16 v[16:19], v[8:11], v[116:119], v[16:19]
    s_cbranch_scc1 L_pk_57
    s_waitcnt vmcnt(8)
L_pk_57:
    buffer_load_dwordx4 v[152:155], v2, s[40:43], s69 offen offset:2048 nt
    s_cbranch_scc1 L_pk_58
    s_waitcnt vmcnt(8)
L_pk_58:
    buffer_load_dwordx4 v[156:159], v2, s[40:43], s69 offen offset:2304 nt
    v_and_b32 v8, v35, v4
    v_and_b32 v9, v35, v5
    v_and_b32 v10, v35, v6
    v_and_b32 v11, v35, v7
    s_waitcnt vmcnt(10)
    s_nop 0
    v_mfma_f32_16x16x32_bf16 v[12:15], v[8:11], v[120:123], v[12:15]
    s_waitcnt vmcnt(9)
    v_mfma_f32_16x16x32_bf16 v[16:19], v[8:11], v[124:127], v[16:19]
    s_cbranch_scc1 L_pk_59
    s_waitcnt vmcnt(8)
L_pk_59:
    buffer_load_dwordx4 v[160:163], v2, s[40:43], s70 offen offset:0 nt
    s_cbranch_scc1 L_pk_60
    s_waitcnt vmcnt(8)
L_pk_60:
    buffer_load_dwordx4 v[164:167], v2, s[40:43], s70 offen offset:256 nt
    v_mov_b32 v49, 0
    v_mov_b32 v50, 0
    v_mov_b32 v51, 0
    s_cmp_ge_u32 s32, 4
    s_cbranch_scc1 L_noprep_61
    v_mov_b32 v44, 0
    ds_read_b128 v[56:59], v44 offset:4112
    ds_read_b64 v[60:61], v44 offset:4128
    v_lshrrev_b32 v47, 5, v1
    v_lshlrev_b32 v47, 2, v47
    s_mov_b32 s72, 0
L_spin_62:
    ds_read_b32 v46, v47 offset:4224
    s_waitcnt lgkmcnt(0)
    v_cmp_eq_u32 vcc, -1, v46
    s_cbranch_vccz L_done_63
    s_sleep 2
    s_add_u32 s72, s72, 1
    s_cmp_lt_u32 s72, 1048576
    s_cbranch_scc1 L_spin_62
L_done_63:
    s_waitcnt lgkmcnt(0)
    v_readlane_b32 s100, v46, 0
    v_readlane_b32 s101, v46, 32
    v_sub_f32 v45, 1.0, v46
    v_readfirstlane_b32 s6, v56
    v_readfirstlane_b32 s7, v57
    v_readfirstlane_b32 s8, v58
    v_readfirstlane_b32 s9, v59
    v_readfirstlane_b32 s10, v60
    v_readfirstlane_b32 s11, v61
    s_waitcnt vmcnt(8)
    s_mov_b32 s72, 0
L_spin_64:
    v_xor_b32 v72, s6, v64
    v_xor_b32 v73, s7, v65
    v_xor_b32 v74, s8, v66
    v_xor_b32 v75, s9, v67
    v_or3_b32 v47, v72, v73, v74
    v_or_b32 v47, v47, v75
    v_and_b32 v47, v3, v47
    v_cmp_ne_u32 vcc, 0, v47
    s_cbranch_vccz L_done_65
    buffer_load_dwordx4 v[64:67], v68, s[48:51], s22 offen sc1
    s_waitcnt vmcnt(0)
    s_add_u32 s72, s72, 1
    s_cmp_lt_u32 s72, 65536
    s_cbranch_scc1 L_spin_64
L_done_65:
    v_add_f32_dpp v72, v72, v72 row_ror:4 row_mask:0xf bank_mask:0xf
    v_add_f32_dpp v73, v73, v73 row_ror:4 row_mask:0xf bank_mask:0xf
    v_add_f32_dpp v74, v74, v74 row_ror:4 row_mask:0xf bank_mask:0xf
    v_add_f32_dpp v75, v75, v75 row_ror:4 row_mask:0xf bank_mask:0xf
    v_add_f32_dpp v64, v72, v72 row_ror:8 row_mask:0xf bank_mask:0xf
    v_add_f32_dpp v65, v73, v73 row_ror:8 row_mask:0xf bank_mask:0xf
    v_add_f32_dpp v66, v74, v74 row_ror:8 row_mask:0xf bank_mask:0xf
    v_add_f32_dpp v67, v75, v75 row_ror:8 row_mask:0xf bank_mask:0xf
    v_lshlrev_b32 v72, 16, v244
    v_and_b32 v73, 0xffff0000, v244
    v_lshlrev_b32 v74, 16, v245
    v_and_b32 v75, 0xffff0000, v245
    v_add_f32 v64, v64, v72
    v_add_f32 v65, v65, v73
    v_add_f32 v66, v66, v74
    v_add_f32 v67, v67, v75
    s_mov_b32 s76, 0xbdd2d3e8
    v_mul_f32 v72, v64, v64
    v_mul_f32 v73, v65, v65
    v_mul_f32 v74, v66, v66
    v_mul_f32 v75, v67, v67
    v_mov_b32 v76, 0xc0135761
    v_fma_f32 v72, v72, s76, v76
    v_fma_f32 v73, v73, s76, v76
    v_fma_f32 v74, v74, s76, v76
    v_fma_f32 v75, v75, s76, v76
    v_mul_f32 v72, v72, v64
    v_mul_f32 v73, v73, v65
    v_mul_f32 v74, v74, v66
    v_mul_f32 v75, v75, v67
    v_exp_f32 v72, v72
    v_exp_f32 v73, v73
    v_exp_f32 v74, v74
    v_exp_f32 v75, v75
    v_add_f32 v72, 1.0, v72
    v_add_f32 v73, 1.0, v73
    v_add_f32 v74, 1.0, v74
    v_add_f32 v75, 1.0, v75
    v_rcp_f32 v72, v72
    v_rcp_f32 v73, v73
    v_rcp_f32 v74, v74
    v_rcp_f32 v75, v75
    v_mul_f32 v64, v64, v72
    v_mul_f32 v65, v65, v73
    v_mul_f32 v66, v66, v74
    v_mul_f32 v67, v67, v75
    v_cvt_pk_bf16_f32 v64, v64, v64
    v_cvt_pk_bf16_f32 v65, v65, v65
    v_cvt_pk_bf16_f32 v66, v66, v66
    v_cvt_pk_bf16_f32 v67, v67, v67
    s_lshl_b32 s75, s32, 8
    v_add_u32 v44, s75, v62
    ds_write_b128 v44, v[64:67] offset:6528
    v_bfe_u32 v48, v1, 3, 1
    v_lshlrev_b32 v48, 5, v48
    v_lshrrev_b32 v47, 4, v1
    v_add_u32 v48, v48, v47
    v_lshlrev_b32 v48, 2, v48
    s_mul_i32 s75, s32, 288
    v_add_u32 v48, s75, v48
    s_waitcnt lgkmcnt(0)
    ds_read_b32 v72, v48 offset:6528
    ds_read_b32 v73, v48 offset:6544
    v_lshlrev_b32 v248, 16, v246
    v_and_b32 v249, 0xffff0000, v246
    v_lshlrev_b32 v250, 16, v247
    v_and_b32 v251, 0xffff0000, v247
    s_waitcnt lgkmcnt(0)
    v_and_b32 v80, v72, v4
    v_and_b32 v81, v72, v5
    v_and_b32 v82, v72, v6
    v_and_b32 v83, v72, v7
    s_nop 1
    v_mfma_f32_16x16x32_bf16 v[248:251], v[80:83], v[236:239], v[248:251]
    v_and_b32 v84, v73, v4
    v_and_b32 v85, v73, v5
    v_and_b32 v86, v73, v6
    v_and_b32 v87, v73, v7
    s_nop 1
    v_mfma_f32_16x16x32_bf16 v[248:251], v[84:87], v[240:243], v[248:251]
    v_bfe_u32 v62, v1, 3, 1
    v_and_b32 v47, 7, v1
    v_lshl_add_u32 v50, v47, 1, v62
    v_lshlrev_b32 v50, 16, v50
    s_lshl_b32 s16, s3, 12
    s_add_u32 s17, s16, 1536
    v_cmp_eq_u32 vcc, 1, v62
    v_mov_b32 v47, s100
    v_mov_b32 v62, s101
    v_cndmask_b32 v62, v47, v62, vcc
    v_lshrrev_b32 v47, 4, v1
    v_lshl_add_u32 v51, v47, 4, v50
    s_and_b32 s77, s14, 3
    s_lshl_b32 s77, s77, 8
    s_add_u32 s16, s16, s77
    s_lshl_b32 s77, s32, 6
    s_add_u32 s16, s16, s77
    v_lshlrev_b32 v49, 2, v0
    v_and_b32 v47, 3, v1
    v_mov_b32 v63, s6
    v_cmp_eq_u32 vcc, 1, v47
    v_mov_b32 v48, s7
    s_nop 0
    v_cndmask_b32 v63, v63, v48, vcc
    v_cmp_eq_u32 vcc, 2, v47
    v_mov_b32 v48, s8
    s_nop 0
    v_cndmask_b32 v63, v63, v48, vcc
    v_cmp_eq_u32 vcc, 3, v47
    v_mov_b32 v48, s9
    s_nop 0
    v_cndmask_b32 v63, v63, v48, vcc
    s_mov_b32 s20, 0x11111111
    s_mov_b32 s21, 0x11111111
    s_add_u32 s18, s73, 1536
    v_mul_f32 v248, v248, v45
    v_mul_f32 v249, v249, v45
    v_mul_f32 v250, v250, v45
    v_mul_f32 v251, v251, v45
L_noprep_61:
    s_nop 1
    s_cmp_ge_u32 s32, 4
    v_and_b32 v8, v36, v4
    v_and_b32 v9, v36, v5
    v_and_b32 v10, v36, v6
    v_and_b32 v11, v36, v7
    s_waitcnt vmcnt(10)
    s_nop 0
    v_mfma_f32_16x16x32_bf16 v[12:15], v[8:11], v[128:131], v[12:15]
    s_waitcnt vmcnt(9)
    v_mfma_f32_16x16x32_bf16 v[16:19], v[8:11], v[132:135], v[16:19]
    s_cbranch_scc1 L_pk_66
    s_waitcnt vmcnt(7)
L_pk_66:
    buffer_load_dwordx4 v[168:171], v2, s[40:43], s70 offen offset:2048 nt
    s_cbranch_scc1 L_pk_67
    s_waitcnt vmcnt(7)
L_pk_67:
    buffer_load_dwordx4 v[172:175], v2, s[40:43], s70 offen offset:2304 nt
    v_and_b32 v8, v37, v4
    v_and_b32 v9, v37, v5
    v_and_b32 v10, v37, v6
    v_and_b32 v11, v37, v7
    s_waitcnt vmcnt(9)
    s_nop 0
    v_mfma_f32_16x16x32_bf16 v[12:15], v[8:11], v[136:139], v[12:15]
    s_waitcnt vmcnt(8)
    v_mfma_f32_16x16x32_bf16 v[16:19], v[8:11], v[140:143], v[16:19]
    s_cbranch_scc1 L_pk_68
    s_waitcnt vmcnt(7)
L_pk_68:
    buffer_load_dwordx4 v[176:179], v2, s[40:43], s71 offen offset:0 nt
    s_cbranch_scc1 L_pk_69
    s_waitcnt vmcnt(7)
L_pk_69:
    buffer_load_dwordx4 v[180:183], v2, s[40:43], s71 offen offset:256 nt
    v_and_b32 v8, v38, v4
    v_and_b32 v9, v38, v5
    v_and_b32 v10, v38, v6
    v_and_b32 v11, v38, v7
    s_waitcnt vmcnt(9)
    s_nop 0
    v_mfma_f32_16x16x32_bf16 v[12:15], v[8:11], v[144:147], v[12:15]
    s_waitcnt vmcnt(8)
    v_mfma_f32_16x16x32_bf16 v[16:19], v[8:11], v[148:151], v[16:19]
    s_cbranch_scc1 L_pk_70
    s_waitcnt vmcnt(7)
L_pk_70:
    buffer_load_dwordx4 v[184:187], v2, s[40:43], s71 offen offset:2048 nt
    s_cbranch_scc1 L_pk_71
    s_waitcnt vmcnt(7)
L_pk_71:
    buffer_load_dwordx4 v[188:191], v2, s[40:43], s71 offen offset:2304 nt
    v_and_b32 v8, v39, v4
    v_and_b32 v9, v39, v5
    v_and_b32 v10, v39, v6
    v_and_b32 v11, v39, v7
    s_waitcnt vmcnt(9)
    s_nop 0
    v_mfma_f32_16x16x32_bf16 v[12:15], v[8:11], v[152:155], v[12:15]
    s_waitcnt vmcnt(8)
    v_mfma_f32_16x16x32_bf16 v[16:19], v[8:11], v[156:159], v[16:19]
    v_and_b32 v8, v40, v4
    v_and_b32 v9, v40, v5
    v_and_b32 v10, v40, v6
    v_and_b32 v11, v40, v7
    s_waitcnt vmcnt(7)
    s_nop 0
    v_mfma_f32_16x16x32_bf16 v[12:15], v[8:11], v[160:163], v[12:15]
    s_waitcnt vmcnt(6)
    v_mfma_f32_16x16x32_bf16 v[16:19], v[8:11], v[164:167], v[16:19]
    v_and_b32 v8, v41, v4
    v_and_b32 v9, v41, v5
    v_and_b32 v10, v41, v6
    v_and_b32 v11, v41, v7
    s_waitcnt vmcnt(5)
    s_nop 0
    v_mfma_f32_16x16x32_bf16 v[12:15], v[8:11], v[168:171], v[12:15]
    s_waitcnt vmcnt(4)
    v_mfma_f32_16x16x32_bf16 v[16:19], v[8:11], v[172:175], v[16:19]
    v_and_b32 v8, v42, v4
    v_and_b32 v9, v42, v5
    v_and_b32 v10, v42, v6
    v_and_b32 v11, v42, v7
    s_waitcnt vmcnt(3)
    s_nop 0
    v_mfma_f32_16x16x32_bf16 v[12:15], v[8:11], v[176:179], v[12:15]
    s_waitcnt vmcnt(2)
    v_mfma_f32_16x16x32_bf16 v[16:19], v[8:11], v[180:183], v[16:19]
    v_and_b32 v8, v43, v4
    v_and_b32 v9, v43, v5
    v_and_b32 v10, v43, v6
    v_and_b32 v11, v43, v7
    s_waitcnt vmcnt(1)
    s_nop 0
    v_mfma_f32_16x16x32_bf16 v[12:15], v[8:11], v[184:187], v[12:15]
    s_waitcnt vmcnt(0)
    v_mfma_f32_16x16x32_bf16 v[16:19], v[8:11], v[188:191], v[16:19]
    v_and_b32 v44, 15, v1
    v_lshrrev_b32 v45, 4, v1
    v_lshlrev_b32 v44, 5, v44
    v_lshl_add_u32 v44, v45, 4, v44
    s_lshl_b32 s75, s32, 10
    v_add_u32 v48, s75, v44
    s_mov_b32 exec_hi, 0
    ds_write_b128 v48, v[12:15] offset:8192
    ds_write_b128 v48, v[16:19] offset:8704
    s_mov_b32 exec_hi, -1
    s_cmp_ge_u32 s32, 4
    s_cbranch_scc1 L_young
    v_mov_b32 v46, 0
    s_mov_b32 s72, 0
L_spin_72:
    ds_read_b128 v[28:31], v46 offset:4160
    ds_read_b128 v[32:35], v46 offset:4176
    ds_read_b128 v[36:39], v46 offset:4192
    ds_read_b128 v[40:43], v46 offset:4208
    s_waitcnt lgkmcnt(0)
    v_max3_u32 v47, v28, v29, v30
    v_max3_u32 v47, v47, v31, v32
    v_max3_u32 v47, v47, v33, v34
    v_max3_u32 v47, v47, v35, v36
    v_max3_u32 v47, v47, v37, v38
    v_max3_u32 v47, v47, v39, v40
    v_max3_u32 v47, v47, v41, v42
    v_max_u32 v47, v47, v43
    v_cmp_eq_u32 vcc, -1, v47
    s_cbranch_vccz L_done_73
    s_sleep 4
    s_add_u32 s72, s72, 1
    s_cmp_lt_u32 s72, 1048576
    s_cbranch_scc1 L_spin_72
L_done_73:
    v_max3_f32 v56, v28, v30, v32
    v_max3_f32 v56, v56, v34, v36
    v_max3_f32 v56, v56, v38, v40
    v_max_f32 v56, v56, v42
    v_sub_f32 v28, v28, v56
    v_sub_f32 v30, v30, v56
    v_sub_f32 v32, v32, v56
    v_sub_f32 v34, v34, v56
    v_sub_f32 v36, v36, v56
    v_sub_f32 v38, v38, v56
    v_sub_f32 v40, v40, v56
    v_sub_f32 v42, v42, v56
    v_exp_f32 v28, v28
    v_exp_f32 v30, v30
    v_exp_f32 v32, v32
    v_exp_f32 v34, v34
    v_exp_f32 v36, v36
    v_exp_f32 v38, v38
    v_exp_f32 v40, v40
    v_exp_f32 v42, v42
    v_mul_f32 v57, v28, v29
    v_fma_f32 v57, v30, v31, v57
    v_fma_f32 v57, v32, v33, v57
    v_fma_f32 v57, v34, v35, v57
    v_fma_f32 v57, v36, v37, v57
    v_fma_f32 v57, v38, v39, v57
    v_fma_f32 v57, v40, v41, v57
    v_fma_f32 v57, v42, v43, v57
    s_cmp_lg_u32 s32, 0
    s_cbranch_scc1 L_noml_74
    v_mov_b32 v58, s10
    v_mov_b32 v59, s11
    s_mov_b64 exec, 1
    buffer_store_dwordx4 v[56:59], v46, s[44:47], s18 offen sc1
    s_mov_b64 exec, -1
L_noml_74:
    s_waitcnt lgkmcnt(0)
    s_barrier
    ds_read2st64_b32 v[64:65], v49 offset0:32 offset1:36
    ds_read2st64_b32 v[66:67], v49 offset0:40 offset1:44
    ds_read2st64_b32 v[68:69], v49 offset0:48 offset1:52
    ds_read2st64_b32 v[70:71], v49 offset0:56 offset1:60
    s_waitcnt lgkmcnt(3)
    v_mul_f32 v52, v64, v28
    v_fma_f32 v52, v65, v30, v52
    s_waitcnt lgkmcnt(2)
    v_fma_f32 v52, v66, v32, v52
    v_fma_f32 v52, v67, v34, v52
    s_waitcnt lgkmcnt(1)
    v_fma_f32 v52, v68, v36, v52
    v_fma_f32 v52, v69, v38, v52
    s_waitcnt lgkmcnt(0)
    v_fma_f32 v52, v70, v40, v52
    v_fma_f32 v52, v71, v42, v52
    v_bfi_b32 v52, v3, v63, v52
    s_nop 1
    v_mov_b32_dpp v53, v52 quad_perm:[1,1,1,1] row_mask:0xf bank_mask:0xf
    v_mov_b32_dpp v54, v52 quad_perm:[2,2,2,2] row_mask:0xf bank_mask:0xf
    v_mov_b32_dpp v55, v52 quad_perm:[3,3,3,3] row_mask:0xf bank_mask:0xf
    s_mov_b64 exec, s[20:21]
    buffer_store_dwordx4 v[52:55], v49, s[44:47], s73 offen sc1
    s_mov_b64 exec, -1
    buffer_load_dwordx4 v[72:75], v50, s[44:47], s17 offen sc1
    buffer_load_dwordx4 v[76:79], v51, s[44:47], s16 offen sc1
    s_mov_b32 s72, 0
L_p1_75:
    s_waitcnt vmcnt(1)
    v_xor_b32 v58, s10, v74
    v_xor_b32 v59, s11, v75
    s_waitcnt vmcnt(0)
    v_xor_b32 v64, s6, v76
    v_xor_b32 v65, s7, v77
    v_xor_b32 v66, s8, v78
    v_xor_b32 v67, s9, v79
    v_or3_b32 v48, v64, v65, v66
    v_or_b32 v48, v48, v67
    v_and_b32 v48, v3, v48
    v_or3_b32 v48, v48, v58, v59
    v_cmp_ne_u32 vcc, 0, v48
    s_cbranch_vccz L_p1g_77
    s_mov_b64 exec, vcc
    buffer_load_dwordx4 v[72:75], v50, s[44:47], s17 offen sc1
    buffer_load_dwordx4 v[76:79], v51, s[44:47], s16 offen sc1
    s_mov_b64 exec, -1
    s_add_u32 s72, s72, 1
    s_cmp_lt_u32 s72, 65536
    s_cbranch_scc1 L_p1_75
L_p1g_77:
    v_mov_b32 v56, v72
    v_mov_b32 v57, v73
L_p1d_76:
    v_mov_b32 v47, v56
    s_nop 1
    v_max_f32_dpp v47, v47, v47 quad_perm:[1,0,3,2] row_mask:0xf bank_mask:0xf
    s_nop 1
    v_max_f32_dpp v47, v47, v47 quad_perm:[2,3,0,1] row_mask:0xf bank_mask:0xf
    s_nop 1
    v_max_f32_dpp v47, v47, v47 row_half_mirror row_mask:0xf bank_mask:0xf
    v_sub_f32 v56, v56, v47
    v_exp_f32 v56, v56
    s_nop 0
    v_mul_f32 v57, v56, v57
    v_mul_f32 v56, v56, v62
    s_nop 0
    v_add_f32_dpp v57, v57, v57 quad_perm:[1,0,3,2] row_mask:0xf bank_mask:0xf
    s_nop 1
    v_add_f32_dpp v57, v57, v57 quad_perm:[2,3,0,1] row_mask:0xf bank_mask:0xf
    s_nop 1
    v_add_f32_dpp v57, v57, v57 row_half_mirror row_mask:0xf bank_mask:0xf
    v_rcp_f32 v57, v57
    s_nop 0
    v_mul_f32 v60, v56, v57
    v_mul_f32 v64, v64, v60
    v_mul_f32 v65, v65, v60
    v_mul_f32 v66, v66, v60
    v_mul_f32 v67, v67, v60
    v_add_f32_dpp v64, v64, v64 quad_perm:[1,0,3,2] row_mask:0xf bank_mask:0xf
    v_add_f32_dpp v65, v65, v65 quad_perm:[1,0,3,2] row_mask:0xf bank_mask:0xf
    v_add_f32_dpp v66, v66, v66 quad_perm:[1,0,3,2] row_mask:0xf bank_mask:0xf
    v_add_f32_dpp v67, v67, v67 quad_perm:[1,0,3,2] row_mask:0xf bank_mask:0xf
    v_add_f32_dpp v64, v64, v64 quad_perm:[2,3,0,1] row_mask:0xf bank_mask:0xf
    v_add_f32_dpp v65, v65, v65 quad_perm:[2,3,0,1] row_mask:0xf bank_mask:0xf
    v_add_f32_dpp v66, v66, v66 quad_perm:[2,3,0,1] row_mask:0xf bank_mask:0xf
    v_add_f32_dpp v67, v67, v67 quad_perm:[2,3,0,1] row_mask:0xf bank_mask:0xf
    v_add_f32_dpp v64, v64, v64 row_half_mirror row_mask:0xf bank_mask:0xf
    v_add_f32_dpp v65, v65, v65 row_half_mirror row_mask:0xf bank_mask:0xf
    v_add_f32_dpp v66, v66, v66 row_half_mirror row_mask:0xf bank_mask:0xf
    v_add_f32_dpp v67, v67, v67 row_half_mirror row_mask:0xf bank_mask:0xf
    v_cvt_pk_bf16_f32 v64, v64, v64
    v_cvt_pk_bf16_f32 v65, v65, v65
    v_cvt_pk_bf16_f32 v66, v66, v66
    v_cvt_pk_bf16_f32 v67, v67, v67
    v_and_b32 v8, v64, v4
    v_and_b32 v9, v64, v5
    v_and_b32 v10, v64, v6
    v_and_b32 v11, v64, v7
    s_nop 1
    v_mfma_f32_16x16x32_bf16 v[248:251], v[8:11], v[208:211], v[248:251]
    v_and_b32 v52, v65, v4
    v_and_b32 v53, v65, v5
    v_and_b32 v54, v65, v6
    v_and_b32 v55, v65, v7
    s_nop 1
    v_mfma_f32_16x16x32_bf16 v[248:251], v[52:55], v[212:215], v[248:251]
    v_and_b32 v8, v66, v4
    v_and_b32 v9, v66, v5
    v_and_b32 v10, v66, v6
    v_and_b32 v11, v66, v7
    s_nop 1
    v_mfma_f32_16x16x32_bf16 v[248:251], v[8:11], v[216:219], v[248:251]
    v_and_b32 v52, v67, v4
    v_and_b32 v53, v67, v5
    v_and_b32 v54, v67, v6
    v_and_b32 v55, v67, v7
    s_nop 1
    v_mfma_f32_16x16x32_bf16 v[248:251], v[52:55], v[220:223], v[248:251]
    v_lshlrev_b32 v48, 4, v1
    s_lshl_b32 s75, s32, 10
    v_add_u32 v49, s75, v48
    s_nop 4
    ds_write_b128 v49, v[248:251] offset:16384
    s_waitcnt lgkmcnt(0)
    s_barrier
    s_cmp_lg_u32 s32, 0
    s_cbranch_scc1 L_fin
    ds_read_b128 v[28:31], v48 offset:16384
    ds_read_b128 v[32:35], v48 offset:17408
    ds_read_b128 v[36:39], v48 offset:18432
    ds_read_b128 v[40:43], v48 offset:19456
    v_and_b32 v50, 15, v1
    v_bfe_u32 v51, v1, 4, 1
    v_lshlrev_b32 v52, 1, v50
    v_add_u32 v52, v52, v51
    v_lshlrev_b32 v52, 4, v52
    v_lshrrev_b32 v53, 5, v1
    v_mul_u32_u24 v53, 512, v53
    v_add_u32 v52, v52, v53
    s_add_u32 s75, s73, 2048
    s_cmp_eq_u32 s15, 3
    s_cselect_b32 s76, 8, 16
    v_cmp_gt_u32 vcc, s76, v50
    s_waitcnt lgkmcnt(2)
    v_add_f32 v28, v28, v32
    v_add_f32 v29, v29, v33
    v_add_f32 v30, v30, v34
    v_add_f32 v31, v31, v35
    s_waitcnt lgkmcnt(0)
    v_add_f32 v36, v36, v40
    v_add_f32 v37, v37, v41
    v_add_f32 v38, v38, v42
    v_add_f32 v39, v39, v43
    v_add_f32 v28, v28, v36
    v_add_f32 v29, v29, v37
    v_add_f32 v30, v30, v38
    v_add_f32 v31, v31, v39
    v_bfi_b32 v28, v3, s6, v28
    v_bfi_b32 v29, v3, s7, v29
    v_bfi_b32 v30, v3, s8, v30
    v_bfi_b32 v31, v3, s9, v31
    s_and_b64 exec, exec, vcc
    buffer_store_dwordx4 v[28:31], v52, s[44:47], s75 offen sc1
    s_mov_b64 exec, -1
    s_cmp_ge_u32 s2, 224
    s_cbranch_scc1 L_fin
    s_lshr_b32 s76, s2, 1
    s_lshr_b32 s77, s76, 5
    s_and_b32 s78, s76, 31
    s_lshl_b32 s78, s78, 4
    s_lshl_b32 s77, s77, 16
    s_add_u32 s75, s77, s78
    s_and_b32 s77, s2, 1
    s_mul_i32 s78, s77, 512
    s_add_u32 s75, s75, s78
    s_add_u32 s75, s75, 2048
    v_lshrrev_b32 v45, 2, v1
    v_and_b32 v46, 3, v1
    v_lshl_add_u32 v45, v46, 6, v45
    v_lshlrev_b32 v45, 12, v45
    s_mul_i32 s77, s77, 896
    s_lshl_b32 s76, s76, 3
    s_add_u32 s76, s76, s77
    v_lshrrev_b32 v53, 4, v1
    v_lshlrev_b32 v53, 2, v53
    s_mov_b32 s48, s26
    s_mov_b32 s49, s27
    s_mov_b32 s50, 1792
    s_mov_b32 s51, 0x20000
    buffer_load_dwordx4 v[136:139], v45, s[44:47], s75 offen sc1
    s_mov_b32 s72, 0
L_p2_78:
    s_waitcnt vmcnt(0)
    v_xor_b32 v48, s6, v136
    v_xor_b32 v49, s7, v137
    v_xor_b32 v50, s8, v138
    v_xor_b32 v51, s9, v139
    v_or3_b32 v52, v48, v49, v50
    v_or_b32 v52, v52, v51
    v_and_b32 v52, v3, v52
    v_cmp_ne_u32 vcc, 0, v52
    s_cbranch_vccz L_p2d_79
    s_mov_b64 exec, vcc
    buffer_load_dwordx4 v[136:139], v45, s[44:47], s75 offen sc1
    s_mov_b64 exec, -1
    s_add_u32 s72, s72, 1
    s_cmp_lt_u32 s72, 65536
    s_cbranch_scc1 L_p2_78
L_p2d_79:
    v_permlane32_swap_b32 v48, v49
    v_permlane32_swap_b32 v50, v51
    v_add_f32 v48, v48, v49
    v_add_f32 v50, v50, v51
    s_nop 1
    v_permlane16_swap_b32 v48, v50
    v_add_f32 v48, v48, v50
    s_nop 1
    v_add_f32_dpp v48, v48, v48 row_ror:8 row_mask:0xf bank_mask:0xf
    s_nop 1
    v_add_f32_dpp v48, v48, v48 row_ror:4 row_mask:0xf bank_mask:0xf
    s_nop 1
    v_add_f32_dpp v48, v48, v48 row_ror:2 row_mask:0xf bank_mask:0xf
    s_nop 1
    v_add_f32_dpp v48, v48, v48 row_ror:1 row_mask:0xf bank_mask:0xf
    v_mov_b32 v49, v48
    s_nop 1
    v_permlane32_swap_b32 v48, v49
    v_cvt_pk_bf16_f32 v48, v48, v49
    s_mov_b64 exec, 0x10001
    buffer_store_dword v48, v53, s[48:51], s76 offen
    s_cmp_lg_u32 s2, 0
    s_cbranch_scc1 L_fin
    v_mov_b32 v50, 0
    v_mov_b32 v51, 0
    s_mov_b64 exec, 1
    s_mov_b32 s60, s28
    s_mov_b32 s61, s29
    s_mov_b32 s62, 256
    s_mov_b32 s63, 0x20000
    buffer_store_dwordx2 v[50:51], v53, s[60:63], 0 offen sc1
    s_branch L_fin
L_young:
    s_waitcnt lgkmcnt(0)
    s_barrier
L_fin:
    s_waitcnt vmcnt(0)
L_end:
    s_endpgm

.section .rodata,"a"
.p2align 6
.amdhsa_kernel gated_mix__mha_block_cached__dense_activation_gelu__decode_kernel
  .amdhsa_next_free_vgpr 256
  .amdhsa_next_free_sgpr 102
  .amdhsa_accum_offset 256
  .amdhsa_group_segment_fixed_size 0
  .amdhsa_kernarg_size 112
  .amdhsa_user_sgpr_count 2
  .amdhsa_user_sgpr_kernarg_segment_ptr 1
  .amdhsa_system_sgpr_workgroup_id_x 1
.end_amdhsa_kernel
```
